```python
import torch

def _softmax(x, axis=-1):
    return torch.softmax(x, dim=axis)

def _gelu(x):
    return torch.nn.functional.gelu(x, approximate='tanh')

def _silu(x):
    return torch.nn.functional.silu(x)

def _sigmoid(x):
    return torch.sigmoid(x)

def _layernorm(x, axis=-1, eps=1e-05):
    m = x.mean(dim=axis, keepdim=True)
    v = x.var(dim=axis, keepdim=True, unbiased=False)
    return (x - m) / torch.sqrt(v + eps)

def _scatter_add(tgt, idx, src, axis=0):
    return tgt.clone().index_add_(axis, idx, src)

def _segment_sum(src, seg, n):
    out = torch.zeros((n,) + src.shape[1:], dtype=src.dtype)
    return out.index_add_(0, seg, src)

def _pad(x, pw):
    flat = tuple((v for pair in reversed(pw) for v in pair))
    return torch.nn.functional.pad(x, flat)
kernel_name = 'adaLN_cond__sliding_block_cached__dense_activation_relu__decode'

def setup_inputs():

    _w = lambda a: (lambda t: t.to(torch.bfloat16) if t.is_floating_point() else t)(torch.as_tensor(a))

    def _A_setup():
        B, Sq, D = (2, 1, 1024)
        Hq, Hkv, Sk, Dh = (32, 4, 32768, 128)
        assert Hq % Hkv == 0, (Hq, Hkv)
        return {'x': _w((lambda *s: torch.randn(*s, dtype=torch.bfloat16) * 0.05)(B, Sq, D)), 'k_cache': _w((lambda *s: torch.randn(*s, dtype=torch.bfloat16) * 0.4)(B, Hkv, Sk, Dh)), 'v_cache': _w((lambda *s: torch.randn(*s, dtype=torch.bfloat16) * 0.8)(B, Hkv, Sk, Dh)), 'wq': _w((lambda *s: torch.randn(*s, dtype=torch.bfloat16) * 0.4)(D, Hq * Dh) * D ** (-0.5)), 'wo': _w((lambda *s: torch.randn(*s, dtype=torch.bfloat16) * 0.8)(Hq * Dh, D) * (Hq * Dh) ** (-0.5))}
    _A_in = _A_setup()

    def _B_setup():
        B, S, D, Dff = (2, 1, 1024, 3584)
        return {'x': _w((lambda *s: torch.randn(*s, dtype=torch.bfloat16) * 0.05)(B, S, D)), 'w1': _w((lambda *s: torch.randn(*s, dtype=torch.bfloat16) * 0.05)(D, Dff)), 'w2': _w((lambda *s: torch.randn(*s, dtype=torch.bfloat16) * 0.05)(Dff, D))}
    _B_in = _B_setup()
    return {'A_x': _A_in['x'], 'A_k_cache': _A_in['k_cache'], 'A_v_cache': _A_in['v_cache'], 'A_wq': _A_in['wq'], 'A_wo': _A_in['wo'], 'B_x': _B_in['x'], 'B_w1': _B_in['w1'], 'B_w2': _B_in['w2'], 'c': _w((lambda *s: torch.randn(*s, dtype=torch.bfloat16) * 0.4)(2, 1024) * 8.0), 'w_mod': _w((lambda *s: torch.randn(*s, dtype=torch.bfloat16) * 0.4)(1024, 6 * 1024) * 1024 ** (-0.5) * 8.0)}

def reference(A_x, A_k_cache, A_v_cache, A_wq, A_wo, B_x, B_w1, B_w2, c, w_mod):

    def _A_ref(x, k_cache, v_cache, wq, wo):
        B, Sq, D = x.shape
        Hq, Dh = (32, 128)
        Hkv, Sk = (k_cache.shape[1], k_cache.shape[2])
        W = min(4096, max(256, Sk // 4))
        rep = Hq // Hkv
        q = (lambda x, *d: x.permute(*d))((x @ wq).reshape(B, Sq, Hq, Dh), 0, 2, 1, 3)
        k = (lambda x, n, axis: torch.repeat_interleave(x, n, dim=axis))(k_cache[:, :, Sk - W:, :], rep, axis=1)
        v = (lambda x, n, axis: torch.repeat_interleave(x, n, dim=axis))(v_cache[:, :, Sk - W:, :], rep, axis=1)
        scores = torch.einsum('bhqd,bhkd->bhqk', q, k) * Dh ** (-0.5)
        p = _softmax(scores, axis=-1)
        o = torch.einsum('bhqk,bhkd->bhqd', p, v)
        return (lambda x, *d: x.permute(*d))(o, 0, 2, 1, 3).reshape(B, Sq, Hq * Dh) @ wo

    def _B_ref(x, w1, w2):
        h = torch.einsum('bsd,df->bsf', x, w1)
        zero = torch.zeros_like(h)
        h = torch.maximum(h, zero)
        return torch.einsum('bsf,fd->bsd', h, w2)
    x = A_x
    mod = (_silu(c) @ w_mod).reshape(c.shape[0], 6, 1, -1)
    sa, ca, ga, sb, cb, gb = (mod[:, 0].clone(), mod[:, 1].clone(), mod[:, 2].clone(), mod[:, 3].clone(), mod[:, 4].clone(), mod[:, 5].clone())
    h = _layernorm(x, axis=-1) * (1 + ca) + sa
    x = x + ga * _A_ref(h, A_k_cache, A_v_cache, A_wq, A_wo)
    h = _layernorm(x, axis=-1) * (1 + cb) + sb
    x = x + gb * _B_ref(h, B_w1, B_w2)
    return x
```

```asm
; @launch grid=(256,1,1) block=(512,1,1) lds=148480
.amdgcn_target "amdgcn-amd-amdhsa--gfx950"
.text
.globl adaLN_cond__sliding_block_cached__dense_activation_relu__decode_kernel
.p2align 8
.type adaLN_cond__sliding_block_cached__dense_activation_relu__decode_kernel,@function
adaLN_cond__sliding_block_cached__dense_activation_relu__decode_kernel:
    s_bitcmp1_b32 s2, 7
    s_cselect_b32 s90, 48, 0
    s_load_dwordx2 s[20:21], s[0:1], s90 offset:24
    s_getpc_b64 s[80:81]
    v_lshlrev_b32 v15, 5, v0
    global_load_dword v250, v15, s[80:81]
    s_cselect_b32 s93, 3, 2
    s_lshl_b32 s22, s93, 22
    s_lshl_b32 s93, s93, 12
    s_mov_b32 s23, 0x20000
    v_bfe_u32 v7, v0, 4, 1
    v_bfe_u32 v15, v0, 5, 1
    v_lshl_add_u32 v7, v7, 2, v15
    v_lshrrev_b32 v15, 6, v0
    v_lshl_add_u32 v211, v15, 4, v7
    v_mul_u32_u24 v211, s93, v211
    v_and_b32 v3, 15, v0
    v_lshl_add_u32 v211, v3, 4, v211
    s_and_b32 s85, s2, 7
    s_bfe_u32 s86, s2, 0x40003
    s_and_b32 s88, s86, 7
    s_and_b32 s91, s86, 8
    s_add_u32 s91, s91, s85
    s_lshl_b32 s92, s86, 1
    s_bitcmp1_b32 s2, 7
    s_cselect_b32 s88, s88, s85
    s_cselect_b32 s91, s91, s92
    s_mul_i32 s90, s88, s93
    s_lshl1_add_u32 s90, s91, s90
    s_lshl_b32 s99, s90, 7
    s_lshl1_add_u32 s90, s93, s99
    s_lshl3_add_u32 s91, s93, s99
    s_lshl3_add_u32 s92, s93, s90
    s_lshr_b32 s93, s2, 8
    s_cbranch_scc1 L_exit
    s_waitcnt lgkmcnt(0)
    buffer_load_dwordx4 v[96:99], v211, s[20:23], s99 offen nt
    buffer_load_dwordx4 v[100:103], v211, s[20:23], s90 offen nt
    buffer_load_dwordx4 v[112:115], v211, s[20:23], s91 offen nt
    buffer_load_dwordx4 v[116:119], v211, s[20:23], s92 offen nt
    s_bitcmp1_b32 s2, 7
    s_cselect_b32 s93, 64, 0
    s_load_dwordx2 s[36:37], s[0:1], s93
    v_readfirstlane_b32 s84, v15
    s_lshl_b32 s88, s88, 8
    s_load_dwordx2 s[4:5], s[0:1], 96
    v_and_b32 v1, 63, v0
    v_bfe_u32 v2, v0, 4, 2
    v_bfe_u32 v4, v1, 2, 1
    v_and_b32 v5, 3, v1
    v_lshl_add_u32 v5, v5, 2, v2
    v_lshl_add_u32 v5, v4, 10, v5
    v_lshlrev_b32 v5, 1, v5
    s_mov_b32 s38, 0x1000
    s_mov_b32 s39, 0x20000
    v_lshl_add_u32 v32, v15, 5, v5
    s_waitcnt lgkmcnt(0)
    buffer_load_ushort v232, v32, s[36:39], s88 offen
    s_cmp_ge_u32 s2, 128
    s_cbranch_scc1 L_progB
    v_lshrrev_b32 v33, 5, v1
    v_lshlrev_b32 v33, 11, v33
    v_and_b32 v32, 31, v1
    v_lshl_add_u32 v33, v32, 3, v33
    v_lshl_add_u32 v33, v15, 8, v33
    buffer_load_dwordx2 v[218:219], v33, s[36:39], 0 offen
    s_load_dwordx2 s[24:25], s[0:1], 32
    s_load_dwordx2 s[32:33], s[0:1], 56
    s_load_dwordx2 s[40:41], s[0:1], 64
    s_load_dwordx2 s[8:9], s[0:1], 72
    s_mul_i32 s101, s85, 0x60000
    s_add_u32 s101, s101, 0x80000
    s_lshl_b32 s93, s86, 3
    s_add_u32 s93, s93, s84
    s_lshl_b32 s93, s93, 7
    s_add_u32 s93, s93, s101
    s_waitcnt lgkmcnt(0)
    s_load_dword s87, s[4:5], 0
    s_mov_b32 s6, 0x800000
    s_mov_b32 s7, 0x20000
    v_mov_b32 v15, 0
    buffer_load_dword v251, v15, s[4:7], s93 offen nt
    s_waitcnt vmcnt(6)
    buffer_load_dwordx4 v[104:107], v211, s[20:23], s99 offen offset:256 nt
    s_waitcnt vmcnt(6)
    buffer_load_dwordx4 v[108:111], v211, s[20:23], s90 offen offset:256 nt
    s_waitcnt vmcnt(6)
    buffer_load_dwordx4 v[120:123], v211, s[20:23], s91 offen offset:256 nt
    s_waitcnt vmcnt(6)
    buffer_load_dwordx4 v[124:127], v211, s[20:23], s92 offen offset:256 nt
    s_branch L_progA
L_progB:
    s_load_dwordx2 s[12:13], s[0:1], 8
    s_load_dwordx2 s[16:17], s[0:1], 16
    s_load_dwordx2 s[28:29], s[0:1], 48
    s_load_dwordx2 s[40:41], s[0:1], 64
    s_load_dwordx2 s[8:9], s[0:1], 72
    s_load_dwordx2 s[44:45], s[0:1], 80
    s_mov_b32 s10, 0xc00000
    s_mov_b32 s11, 0x20000
    s_mov_b32 s42, 0x1000
    s_mov_b32 s43, 0x20000
    s_and_b32 s90, s86, 8
    s_mul_i32 s90, s90, 12032
    s_add_u32 s90, s90, s99
    s_add_u32 s90, s90, 6144
    v_add_u32 v226, s90, v211
    s_waitcnt lgkmcnt(0)
    s_load_dword s87, s[4:5], 0
    s_load_dwordx2 s[36:37], s[0:1], 0
    s_lshl_b32 s88, s85, 23
    s_lshl_b32 s91, s86, 16
    s_add_u32 s88, s88, s91
    s_lshl_b32 s91, s84, 10
    s_add_u32 s88, s88, s91
    s_add_u32 s88, s88, 0x700000
    v_xor_b32 v15, v3, v2
    v_lshlrev_b32 v15, 4, v15
    v_lshl_add_u32 v228, v2, 8, v15
    v_xor_b32 v229, 64, v228
    v_xor_b32 v230, 128, v228
    v_xor_b32 v231, 192, v228
    v_lshlrev_b32 v15, 1, v2
    v_xor_b32 v15, v3, v15
    v_lshlrev_b32 v15, 4, v15
    v_lshl_add_u32 v224, v2, 8, v15
    v_xor_b32 v225, 128, v224
    s_mov_b32 s14, 0x4000000
    s_mov_b32 s15, 0x20000
    s_mov_b32 s18, 0x4000000
    s_mov_b32 s19, 0x20000
    s_mov_b32 s38, 0x1000
    s_mov_b32 s39, 0x20000
    s_load_dwordx2 s[24:25], s[0:1], 32
    s_mov_b32 s26, 0x800000
    s_mov_b32 s27, 0x20000
    s_mov_b32 s94, 0xffffff00
    s_mov_b32 s95, 0xffff0000
    s_mov_b32 s97, 0
    s_mov_b32 s6, 0x800000
    s_mov_b32 s7, 0x20000
    s_mov_b32 s30, 0x700000
    s_mov_b32 s31, 0x20000
    s_mov_b32 s46, 0x1000
    s_mov_b32 s47, 0x20000
    s_mul_i32 s101, s85, 0x60000
    s_add_u32 s101, s101, 0x80000
    v_and_b32 v6, 3, v1
    v_mul_u32_u24 v6, 0x5555, v6
    v_mov_b32 v16, 0
    v_mov_b32 v17, 0
    v_mov_b32 v18, 0
    v_mov_b32 v19, 0
    v_mov_b32 v20, 0
    v_mov_b32 v21, 0
    v_mov_b32 v22, 0
    v_mov_b32 v23, 0
    v_mov_b32 v8, 0
    v_lshrrev_b32 v11, 3, v1
    v_lshlrev_b32 v11, 10, v11
    v_and_b32 v15, 7, v1
    v_lshl_add_u32 v11, v15, 4, v11
    s_lshl_b32 s90, s84, 7
    v_add_u32 v11, s90, v11
    s_mul_i32 s90, s84, 1280
    v_mul_u32_u24 v12, 288, v2
    v_lshl_add_u32 v12, v3, 4, v12
    v_add_u32 v12, s90, v12
    s_and_b32 s90, s84, 3
    s_lshl_b32 s90, s90, 6
    v_add_u32 v32, s90, v1
    v_lshlrev_b32 v14, 2, v32
    s_lshr_b32 s90, s84, 2
    s_mul_i32 s90, s90, 10240
    v_and_b32 v33, 3, v32
    v_lshl_add_u32 v33, v33, 2, s90
    v_bfe_u32 v34, v32, 2, 1
    v_bfe_u32 v35, v32, 4, 1
    v_lshl_add_u32 v35, v34, 1, v35
    v_mul_u32_u24 v13, 288, v35
    v_lshrrev_b32 v35, 5, v32
    v_bfe_u32 v36, v32, 3, 1
    v_lshl_add_u32 v35, v35, 1, v36
    v_lshl_add_u32 v13, v35, 4, v13
    v_add_u32 v13, v13, v33
    s_waitcnt lgkmcnt(0)
    s_add_u32 s87, s87, 1
    s_and_b32 s90, s87, 0xff
    v_mov_b32 v10, s90
    v_mov_b32 v70, s87
    v_mov_b32 v24, 0
    v_mov_b32 v25, 0
    v_mov_b32 v26, 0
    v_mov_b32 v27, 0
    s_add_u32 s89, s88, 0
    s_lshl_b32 s90, s84, 13
    s_add_u32 m0, s90, 0
    s_nop 0
    buffer_load_dwordx4 v228, s[12:15], s89 offen nt lds
    s_add_u32 s89, s88, 7168
    buffer_load_dwordx4 v229, s[12:15], s89 offen offset:1024 nt lds
    s_waitcnt vmcnt(2)
    v_lshlrev_b32 v40, 16, v232
    v_mul_f32 v41, 0xbfb8aa3b, v40
    v_exp_f32 v41, v41
    s_nop 0
    v_add_f32 v41, 1.0, v41
    v_rcp_f32 v42, v41
    s_nop 0
    v_mul_f32 v43, v40, v42
    v_cvt_pk_bf16_f32 v64, v43, 0
    s_nop 1
    v_mov_b32_dpp v16, v64 quad_perm:[0,0,0,0] row_mask:0xf bank_mask:0x3
    v_mov_b32_dpp v17, v64 quad_perm:[0,0,0,0] row_mask:0xf bank_mask:0xc
    v_mov_b32_dpp v18, v64 quad_perm:[1,1,1,1] row_mask:0xf bank_mask:0x3
    v_mov_b32_dpp v19, v64 quad_perm:[1,1,1,1] row_mask:0xf bank_mask:0xc
    v_mov_b32_dpp v20, v64 quad_perm:[2,2,2,2] row_mask:0xf bank_mask:0x3
    v_mov_b32_dpp v21, v64 quad_perm:[2,2,2,2] row_mask:0xf bank_mask:0xc
    v_mov_b32_dpp v22, v64 quad_perm:[3,3,3,3] row_mask:0xf bank_mask:0x3
    v_mov_b32_dpp v23, v64 quad_perm:[3,3,3,3] row_mask:0xf bank_mask:0xc
    v_smfmac_f32_16x16x64_bf16 v[24:27], v[16:19], v[96:103], v6
    s_nop 0
    v_smfmac_f32_16x16x64_bf16 v[24:27], v[20:23], v[112:119], v6
    s_lshl_b32 s92, s86, 10
    s_add_u32 s92, s92, s101
    v_add_u32 v15, 131072, v12
    s_nop 4
    ds_write_b128 v15, v[24:27] offset:0
    s_waitcnt lgkmcnt(0)
    s_barrier
    s_cmp_ge_u32 s84, 4
    s_cbranch_scc1 L_pub_1
    v_add_u32 v15, 131072, v13
    ds_read2st64_b32 v[32:33], v15 offset0:0 offset1:5
    ds_read2st64_b32 v[34:35], v15 offset0:10 offset1:15
    ds_read2st64_b32 v[36:37], v15 offset0:20 offset1:25
    ds_read2st64_b32 v[38:39], v15 offset0:30 offset1:35
    s_waitcnt lgkmcnt(2)
    v_add_f32 v32, v32, v33
    v_add_f32 v34, v34, v35
    s_waitcnt lgkmcnt(0)
    v_add_f32 v36, v36, v37
    v_add_f32 v38, v38, v39
    v_add_f32 v32, v32, v34
    v_add_f32 v36, v36, v38
    v_add_f32 v32, v32, v36
    v_and_or_b32 v32, v32, s94, v10
    buffer_store_dword v32, v14, s[4:7], s92 offen
L_pub_1:
    s_barrier
    s_add_u32 s89, s88, 14336
    buffer_load_dwordx4 v230, s[12:15], s89 offen offset:2048 nt lds
    s_add_u32 s89, s88, 21504
    buffer_load_dwordx4 v231, s[12:15], s89 offen offset:3072 nt lds
    s_add_u32 s89, s88, 32768
    s_waitcnt vmcnt(3)
    s_lshl_b32 s90, s84, 13
    s_add_u32 m0, s90, 4096
    s_nop 0
    buffer_load_dwordx4 v228, s[12:15], s89 offen nt lds
    s_add_u32 s89, s88, 39936
    s_waitcnt vmcnt(3)
    buffer_load_dwordx4 v229, s[12:15], s89 offen offset:1024 nt lds
    s_cmp_lt_u32 s86, 8
    s_cbranch_scc1 L_B_norot
    v_mov_b32_dpp v64, v64 quad_perm:[2,3,2,3] row_mask:0xf bank_mask:0xf
L_B_norot:
    s_lshl_b32 s92, s85, 7
    s_lshl_b32 s91, s84, 4
    s_add_u32 s92, s92, s91
    s_min_u32 s91, s86, 13
    s_lshl_b32 s91, s91, 9
    s_mul_i32 s92, s92, 7168
    s_add_u32 s92, s92, s91
    v_mul_u32_u24 v227, 7168, v7
    v_lshl_add_u32 v227, v3, 4, v227
    v_add_u32 v227, s92, v227
    s_lshl_b32 s90, s84, 9
    v_lshl_add_u32 v240, v1, 3, s90
    v_and_b32 v249, 7, v1
    v_lshl_add_u32 v249, v2, 3, v249
    s_lshl_b32 s90, s84, 9
    v_lshl_add_u32 v249, v249, 4, s90
    s_mul_i32 s90, s84, 272
    s_add_u32 s90, s90, 141312
    v_lshl_add_u32 v241, v1, 2, s90
    v_and_b32 v32, 7, v1
    v_mul_u32_u24 v242, 272, v32
    v_lshl_add_u32 v242, v2, 4, v242
    v_add_u32 v242, 141312, v242
    v_lshlrev_b32 v244, 5, v32
    v_add_u32 v244, 147712, v244
    s_lshl_b32 s90, s84, 2
    v_add_u32 v245, s90, v244
    v_bfe_u32 v34, v1, 3, 2
    v_lshlrev_b32 v34, 2, v34
    v_lshl_add_u32 v34, v32, 4, v34
    v_lshrrev_b32 v33, 5, v1
    v_lshl_add_u32 v34, v33, 8, v34
    s_lshl_b32 s90, s84, 9
    s_add_u32 s90, s90, 143616
    v_add_u32 v246, s90, v34
    v_lshlrev_b32 v247, 4, v1
    v_add_u32 v247, 143616, v247
    v_bfe_u32 v184, v1, 3, 1
    v_mul_u32_u24 v184, 0xaaaa, v184
    v_add_u32 v184, 0x4444, v184
    v_mov_b32 v176, 0x3f803f80
    v_mov_b32 v177, 0x3f803f80
    v_mov_b32 v178, 0x3f803f80
    v_mov_b32 v179, 0x3f803f80
    v_lshrrev_b32 v15, 2, v1
    v_and_b32 v36, 7, v15
    v_lshlrev_b32 v36, 1, v36
    v_bfe_u32 v37, v1, 1, 1
    s_lshl_b32 s90, s84, 1
    v_add_u32 v37, s90, v37
    v_xor_b32 v36, v36, v37
    v_lshlrev_b32 v243, 8, v15
    v_lshl_add_u32 v243, v36, 4, v243
    v_and_b32 v37, 1, v1
    v_lshl_add_u32 v243, v37, 3, v243
    v_add_u32 v243, 65536, v243
    v_and_b32 v248, 1, v2
    v_lshlrev_b32 v248, 11, v248
    v_lshl_add_u32 v248, v33, 10, v248
    v_lshl_add_u32 v248, v3, 2, v248
    s_and_b32 s92, s86, 1
    s_lshl_b32 s92, s92, 3
    s_add_u32 s92, s92, s84
    v_lshrrev_b32 v15, 3, v1
    s_lshl_b32 s90, s92, 8
    v_lshl_add_u32 v252, v32, 4, s90
    v_lshl_add_u32 v252, v15, 12, v252
    s_lshl_b32 s91, s85, 12
    s_add_u32 s90, s90, s91
    s_add_u32 s100, s90, 0x41000
    s_lshr_b32 s90, s92, 1
    s_lshl_b32 s90, s90, 4
    v_lshl_add_u32 v253, v15, 7, s90
    v_and_b32 v254, 3, v1
    v_lshl_add_u32 v254, v2, 2, v254
    v_lshlrev_b32 v254, 3, v254
    v_lshl_add_u32 v254, v4, 2, v254
    v_xor_b32 v15, v3, v2
    v_lshlrev_b32 v15, 4, v15
    v_lshl_add_u32 v236, v3, 8, v15
    s_lshl_b32 s90, s84, 13
    v_add_u32 v236, s90, v236
    v_xor_b32 v237, 64, v236
    v_xor_b32 v238, 128, v236
    v_xor_b32 v239, 192, v236
    v_mov_b32 v72, 0
    v_mov_b32 v73, 0
    v_mov_b32 v74, 0
    v_mov_b32 v75, 0
    v_mov_b32 v76, 0
    v_mov_b32 v77, 0
    v_mov_b32 v78, 0
    v_mov_b32 v79, 0
    v_mov_b32 v28, 0
    v_mov_b32 v29, 0
    v_mov_b32 v30, 0
    v_mov_b32 v31, 0
    s_lshl_b32 s90, s86, 12
    s_lshl_b32 s91, s84, 6
    s_add_u32 s90, s90, s91
    s_add_u32 s90, s90, s101
    s_add_u32 s82, s90, 0x16000
    s_lshl_b32 s90, s86, 7
    s_add_u32 s90, s90, s101
    s_add_u32 s83, s90, 0x26000
    s_mov_b32 s98, 0x3e0293ee
    s_mov_b32 s99, 0x3e0293ee
    s_add_u32 s89, s88, 47104
    s_waitcnt vmcnt(3)
    buffer_load_dwordx4 v230, s[12:15], s89 offen offset:2048 nt lds
    s_add_u32 s89, s88, 54272
    s_waitcnt vmcnt(3)
    buffer_load_dwordx4 v231, s[12:15], s89 offen offset:3072 nt lds
    s_add_u32 s89, s88, 0
    s_waitcnt vmcnt(3)
    s_lshl_b32 s90, s84, 13
    s_add_u32 m0, s90, 65536
    s_nop 0
    buffer_load_dwordx4 v224, s[16:19], s89 offen nt lds
    s_add_u32 s89, s88, 7168
    s_waitcnt vmcnt(3)
    buffer_load_dwordx4 v225, s[16:19], s89 offen offset:1024 nt lds
    s_add_u32 s89, s88, 14336
    s_waitcnt vmcnt(3)
    buffer_load_dwordx4 v224, s[16:19], s89 offen offset:2048 nt lds
    s_add_u32 s89, s88, 21504
    s_waitcnt vmcnt(3)
    buffer_load_dwordx4 v225, s[16:19], s89 offen offset:3072 nt lds
    ds_read_b128 v[80:83], v236 offset:0
    ds_read_b128 v[84:87], v237 offset:0
    ds_read_b128 v[88:91], v238 offset:0
    ds_read_b128 v[92:95], v239 offset:0
    ds_read_b128 v[96:99], v236 offset:4096
    ds_read_b128 v[100:103], v237 offset:4096
    ds_read_b128 v[104:107], v238 offset:4096
    ds_read_b128 v[108:111], v239 offset:4096
    s_add_u32 s76, s101, 0x14000
    buffer_load_dwordx2 v[32:33], v240, s[4:7], s76 offen sc1
    s_add_u32 s89, s88, 32768
    s_waitcnt vmcnt(4)
    s_lshl_b32 s90, s84, 13
    s_add_u32 m0, s90, 69632
    s_nop 0
    buffer_load_dwordx4 v224, s[16:19], s89 offen nt lds
    buffer_load_dwordx2 v[180:181], v240, s[4:7], s76 offen sc1
    s_add_u32 s89, s88, 39936
    s_waitcnt vmcnt(5)
    buffer_load_dwordx4 v225, s[16:19], s89 offen offset:1024 nt lds
    buffer_load_dwordx2 v[182:183], v240, s[4:7], s76 offen sc1
    s_add_u32 s89, s88, 47104
    s_waitcnt vmcnt(6)
    buffer_load_dwordx4 v224, s[16:19], s89 offen offset:2048 nt lds
    buffer_load_dwordx2 v[186:187], v240, s[4:7], s76 offen sc1
    s_add_u32 s89, s88, 54272
    s_waitcnt vmcnt(7)
    buffer_load_dwordx4 v225, s[16:19], s89 offen offset:3072 nt lds
    s_waitcnt vmcnt(7)
    v_xor_b32 v15, v32, v10
    v_bitop3_b32 v15, v15, v33, v10 bitop3:0xf6
    v_cmp_ne_u32_sdwa vcc, v15, v8 src0_sel:BYTE_0 src1_sel:DWORD
    s_cbranch_vccz L_B_qok
    s_waitcnt vmcnt(5)
    v_mov_b32 v32, v180
    v_mov_b32 v33, v181
    v_xor_b32 v15, v32, v10
    v_bitop3_b32 v15, v15, v33, v10 bitop3:0xf6
    v_cmp_ne_u32_sdwa vcc, v15, v8 src0_sel:BYTE_0 src1_sel:DWORD
    s_cbranch_vccz L_B_qok
    s_waitcnt vmcnt(3)
    v_mov_b32 v32, v182
    v_mov_b32 v33, v183
    v_xor_b32 v15, v32, v10
    v_bitop3_b32 v15, v15, v33, v10 bitop3:0xf6
    v_cmp_ne_u32_sdwa vcc, v15, v8 src0_sel:BYTE_0 src1_sel:DWORD
    s_cbranch_vccz L_B_qok
    s_waitcnt vmcnt(1)
    v_mov_b32 v32, v186
    v_mov_b32 v33, v187
    v_xor_b32 v15, v32, v10
    v_bitop3_b32 v15, v15, v33, v10 bitop3:0xf6
    v_cmp_ne_u32_sdwa vcc, v15, v8 src0_sel:BYTE_0 src1_sel:DWORD
    s_cbranch_vccz L_B_qok
    s_add_u32 s76, s101, 0x14000
    s_mov_b32 s96, 1
    s_branch L_poll_2
L_retry_4:
    s_sleep 1
    s_add_u32 s96, s96, 1
    s_cmp_ge_u32 s96, 48
    s_cbranch_scc1 L_rare_5
L_back_6:
L_poll_2:
    buffer_load_dwordx2 v[32:33], v240, s[4:7], s76 offen sc1
    s_waitcnt vmcnt(0)
    v_xor_b32 v15, v32, v10
    v_bitop3_b32 v15, v15, v33, v10 bitop3:0xf6
    v_cmp_ne_u32_sdwa vcc, v15, v8 src0_sel:BYTE_0 src1_sel:DWORD
    s_cbranch_vccnz L_retry_4
L_ok_3:
L_B_qok:
    v_cvt_pk_bf16_f32 v32, v32, v33
    ds_write_b32 v241, v32
    s_waitcnt lgkmcnt(0)
    s_barrier
    ds_read_b128 v[32:35], v242 offset:0
    ds_read_b128 v[36:39], v242 offset:64
    ds_read_b128 v[40:43], v242 offset:128
    ds_read_b128 v[44:47], v242 offset:192
    s_waitcnt lgkmcnt(3)
    v_mfma_f32_16x16x32_bf16 v[48:51], v[80:83], v[32:35], 0
    v_mfma_f32_16x16x32_bf16 v[52:55], v[96:99], v[32:35], 0
    s_waitcnt lgkmcnt(2)
    v_mfma_f32_16x16x32_bf16 v[48:51], v[84:87], v[36:39], v[48:51]
    v_mfma_f32_16x16x32_bf16 v[52:55], v[100:103], v[36:39], v[52:55]
    s_waitcnt lgkmcnt(1)
    v_mfma_f32_16x16x32_bf16 v[48:51], v[88:91], v[40:43], v[48:51]
    v_mfma_f32_16x16x32_bf16 v[52:55], v[104:107], v[40:43], v[52:55]
    s_waitcnt lgkmcnt(0)
    v_mfma_f32_16x16x32_bf16 v[48:51], v[92:95], v[44:47], v[48:51]
    v_mfma_f32_16x16x32_bf16 v[52:55], v[108:111], v[44:47], v[52:55]
    ds_read_b64_tr_b16 v[112:113], v243 offset:0
    ds_read_b64_tr_b16 v[116:117], v243 offset:8192
    ds_read_b64_tr_b16 v[120:121], v243 offset:16384
    ds_read_b64_tr_b16 v[124:125], v243 offset:24576
    ds_read_b64_tr_b16 v[128:129], v243 offset:32768
    ds_read_b64_tr_b16 v[132:133], v243 offset:40960
    ds_read_b64_tr_b16 v[136:137], v243 offset:49152
    ds_read_b64_tr_b16 v[140:141], v243 offset:57344
    v_mov_b32_dpp v48, v52 quad_perm:[0,1,2,3] row_mask:0xf bank_mask:0xc
    v_mov_b32_dpp v49, v53 quad_perm:[0,1,2,3] row_mask:0xf bank_mask:0xc
    v_mov_b32_dpp v50, v54 quad_perm:[0,1,2,3] row_mask:0xf bank_mask:0xc
    v_mov_b32_dpp v51, v55 quad_perm:[0,1,2,3] row_mask:0xf bank_mask:0xc
    v_max3_f32 v60, v48, v49, v50
    v_max_f32 v60, v60, v51
    s_nop 1
    v_max_f32_dpp v60, v60, v60 row_ror:8 row_mask:0xf bank_mask:0xf
    v_mov_b32 v61, v60
    s_nop 1
    v_permlane16_swap_b32 v60, v61
    v_max_f32 v60, v60, v61
    v_mov_b32 v61, v60
    s_nop 1
    v_permlane32_swap_b32 v60, v61
    v_max_f32 v60, v60, v61
    ds_write_b32 v245, v60
    s_waitcnt lgkmcnt(0)
    s_barrier
    ds_read_b128 v[32:35], v244
    ds_read_b128 v[36:39], v244 offset:16
    s_waitcnt lgkmcnt(0)
    v_max3_f32 v60, v32, v33, v34
    v_max3_f32 v61, v35, v36, v37
    v_max3_f32 v60, v60, v38, v39
    v_max_f32 v60, v60, v61
    v_mul_f32 v60, 0x3e0293ee, v60
    v_pk_fma_f32 v[48:49], v[48:49], s[98:99], v[60:61] op_sel_hi:[1,1,0] neg_lo:[0,0,1] neg_hi:[0,0,1]
    v_pk_fma_f32 v[50:51], v[50:51], s[98:99], v[60:61] op_sel_hi:[1,1,0] neg_lo:[0,0,1] neg_hi:[0,0,1]
    v_exp_f32 v48, v48
    v_exp_f32 v49, v49
    v_exp_f32 v50, v50
    v_exp_f32 v51, v51
    v_cvt_pk_bf16_f32 v56, v48, v49
    v_cvt_pk_bf16_f32 v57, v50, v51
    ds_write2_b32 v246, v56, v57 offset0:0 offset1:32
    s_cmp_lg_u32 s84, 7
    s_waitcnt lgkmcnt(0)
    s_barrier
    ds_read_b128 v[144:147], v247 offset:0
    ds_read_b128 v[148:151], v247 offset:1024
    ds_read_b128 v[152:155], v247 offset:2048
    ds_read_b128 v[156:159], v247 offset:3072
    s_waitcnt vmcnt(0)
    s_barrier
    ds_read_b64_tr_b16 v[114:115], v243 offset:4096
    ds_read_b64_tr_b16 v[118:119], v243 offset:12288
    ds_read_b64_tr_b16 v[122:123], v243 offset:20480
    ds_read_b64_tr_b16 v[126:127], v243 offset:28672
    ds_read_b64_tr_b16 v[130:131], v243 offset:36864
    ds_read_b64_tr_b16 v[134:135], v243 offset:45056
    ds_read_b64_tr_b16 v[138:139], v243 offset:53248
    ds_read_b64_tr_b16 v[142:143], v243 offset:61440
    s_cbranch_scc1 L_B_noml
    v_mov_b32 v61, v60
    v_mov_b32 v60, v70
    v_mov_b32 v63, v70
    v_and_b32 v15, 7, v1
    v_lshlrev_b32 v15, 4, v15
    s_waitcnt lgkmcnt(8)
    v_mfma_f32_16x16x32_bf16 v[188:191], v[176:179], v[144:147], 0
    v_mfma_f32_16x16x32_bf16 v[188:191], v[176:179], v[148:151], v[188:191]
    v_mfma_f32_16x16x32_bf16 v[188:191], v[176:179], v[152:155], v[188:191]
    v_mfma_f32_16x16x32_bf16 v[188:191], v[176:179], v[156:159], v[188:191]
L_B_noml:
    s_waitcnt lgkmcnt(6)
    v_smfmac_f32_16x16x64_bf16 v[28:31], v[144:147], v[112:119], v184
    s_waitcnt lgkmcnt(4)
    v_smfmac_f32_16x16x64_bf16 v[28:31], v[148:151], v[120:127], v184
    s_waitcnt lgkmcnt(2)
    v_smfmac_f32_16x16x64_bf16 v[28:31], v[152:155], v[128:135], v184
    s_waitcnt lgkmcnt(0)
    v_smfmac_f32_16x16x64_bf16 v[28:31], v[156:159], v[136:143], v184
    s_cbranch_scc1 L_B_noml2
    v_add_f32_dpp v62, v188, v188 row_ror:8 row_mask:0xf bank_mask:0xf
    buffer_store_dwordx4 v[60:63], v15, s[4:7], s83 offen
L_B_noml2:
    s_nop 6
    v_permlane32_swap_b32 v28, v30
    v_permlane32_swap_b32 v29, v31
    v_add_f32 v28, v28, v30
    v_add_f32 v29, v29, v31
    v_and_or_b32 v28, v28, s94, v10
    buffer_store_dword v28, v248, s[4:7], s82 offen offset:0
    v_and_or_b32 v29, v29, s94, v10
    buffer_store_dword v29, v248, s[4:7], s82 offen offset:512
    s_cmp_lg_u32 s84, 7
    s_cbranch_scc1 L_hs_9
    s_lshl_b32 s90, s86, 2
    s_add_u32 s90, s90, s101
    s_add_u32 s90, s90, 0x15000
    s_mov_b64 exec, 1
    buffer_store_dword v70, v1, s[4:7], s90 offen
    s_mov_b64 exec, -1
L_hs_9:
L_B_pvdone:
    s_cmp_ge_u32 s86, 14
    s_cbranch_scc1 L_B_spare
    s_barrier
    buffer_load_dwordx4 v[160:163], v226, s[8:11], 0 offen nt
    buffer_load_dwordx4 v[168:171], v226, s[8:11], 0 offen offset:2048 nt
    s_mov_b32 s90, 0x6000
    buffer_load_dwordx4 v[164:167], v226, s[8:11], s90 offen nt
    s_mov_b32 s90, 0x6000
    buffer_load_dwordx4 v[172:175], v226, s[8:11], s90 offen offset:2048 nt
    s_waitcnt vmcnt(3)
    buffer_load_dwordx4 v[192:195], v227, s[28:31], 0 offen nt
    s_waitcnt vmcnt(3)
    buffer_load_dwordx4 v[200:203], v227, s[28:31], 0 offen offset:256 nt
    s_waitcnt vmcnt(3)
    s_mov_b32 s90, 0x3800
    buffer_load_dwordx4 v[196:199], v227, s[28:31], s90 offen nt
    s_waitcnt vmcnt(3)
    s_mov_b32 s90, 0x3800
    buffer_load_dwordx4 v[204:207], v227, s[28:31], s90 offen offset:256 nt
    v_mov_b32_dpp v16, v64 quad_perm:[0,0,0,0] row_mask:0xf bank_mask:0x3
    v_mov_b32_dpp v17, v64 quad_perm:[0,0,0,0] row_mask:0xf bank_mask:0xc
    v_mov_b32_dpp v18, v64 quad_perm:[1,1,1,1] row_mask:0xf bank_mask:0x3
    v_mov_b32_dpp v19, v64 quad_perm:[1,1,1,1] row_mask:0xf bank_mask:0xc
    s_nop 1
    v_smfmac_f32_16x16x64_bf16 v[72:75], v[16:19], v[160:167], v6
    v_smfmac_f32_16x16x64_bf16 v[76:79], v[16:19], v[168:175], v6
    s_cmp_lt_u32 s84, 4
    s_cselect_b32 s92, 0x24000, 0
    s_add_u32 s92, s92, s101
    s_lshl_b32 s91, s86, 10
    s_add_u32 s92, s92, s91
    s_add_u32 s92, s92, 0x8000
    s_nop 0
    ds_write_b128 v12, v[72:75] offset:0
    ds_write_b128 v12, v[76:79] offset:10240
    s_waitcnt lgkmcnt(0)
    s_barrier
    ds_read2st64_b32 v[32:33], v13 offset0:0 offset1:5
    ds_read2st64_b32 v[34:35], v13 offset0:10 offset1:15
    ds_read2st64_b32 v[36:37], v13 offset0:20 offset1:25
    ds_read2st64_b32 v[38:39], v13 offset0:30 offset1:35
    s_waitcnt lgkmcnt(2)
    v_add_f32 v32, v32, v33
    v_add_f32 v34, v34, v35
    s_waitcnt lgkmcnt(0)
    v_add_f32 v36, v36, v37
    v_add_f32 v38, v38, v39
    v_add_f32 v32, v32, v34
    v_add_f32 v36, v36, v38
    v_add_f32 v32, v32, v36
    v_and_or_b32 v32, v32, s94, v10
    buffer_store_dword v32, v14, s[4:7], s92 offen
L_pub_10:
    s_barrier
    v_mov_b32 v76, 0
    v_mov_b32 v77, 0
    v_mov_b32 v78, 0
    v_mov_b32 v79, 0
    s_waitcnt vmcnt(3)
    s_mov_b32 s90, 0xe000
    buffer_load_dwordx4 v[208:211], v227, s[28:31], s90 offen nt
    s_waitcnt vmcnt(3)
    s_mov_b32 s90, 0xe000
    buffer_load_dwordx4 v[216:219], v227, s[28:31], s90 offen offset:256 nt
    s_waitcnt vmcnt(3)
    s_mov_b32 s90, 0x11800
    buffer_load_dwordx4 v[212:215], v227, s[28:31], s90 offen nt
    s_waitcnt vmcnt(3)
    s_mov_b32 s90, 0x11800
    buffer_load_dwordx4 v[220:223], v227, s[28:31], s90 offen offset:256 nt
    s_lshl_b32 s92, s86, 4
    s_add_u32 s92, s92, s85
    s_lshl_b32 s92, s92, 10
    s_add_u32 s92, s92, 0x380000
    s_lshr_b32 s90, s84, 2
    s_mul_i32 s90, s90, 8192
    s_add_u32 s92, s92, s90
    v_mov_b32 v24, 0
    v_mov_b32 v25, 0
    v_mov_b32 v26, 0
    v_mov_b32 v27, 0
    v_mov_b32 v28, 0
    v_mov_b32 v29, 0
    v_mov_b32 v30, 0
    v_mov_b32 v31, 0
    s_lshl_b32 s90, s86, 2
    s_add_u32 s90, s90, 0x15080
    v_mov_b32 v69, s90
    s_lshr_b32 s90, s84, 2
    s_mul_i32 s90, s90, 10240
    v_and_b32 v9, 1, v1
    v_lshl_add_u32 v9, v9, 1, v4
    v_mul_u32_u24 v9, 288, v9
    v_lshrrev_b32 v15, 3, v1
    v_lshl_add_u32 v9, v15, 5, v9
    v_bfe_u32 v15, v1, 1, 1
    v_lshl_add_u32 v9, v15, 4, v9
    v_add_u32 v9, s90, v9
    v_lshrrev_b32 v88, 3, v1
    v_lshlrev_b32 v88, 7, v88
    v_lshl_add_u32 v88, v4, 3, v88
    s_lshl_b32 s93, s85, 10
    s_add_u32 s93, s93, 0x49000
    s_add_u32 s76, s101, 0x26800
    buffer_load_dwordx4 v[80:83], v249, s[4:7], s76 offen sc1
    s_waitcnt vmcnt(0)
    v_xor_b32 v15, v80, v10
    v_bitop3_b32 v15, v15, v83, v10 bitop3:0xf6
    v_cmp_ne_u32_sdwa vcc, v15, v8 src0_sel:BYTE_0 src1_sel:DWORD
    s_cbranch_vccz L_B_recok
    s_add_u32 s76, s101, 0x26800
    s_mov_b32 s96, 1
    s_branch L_poll_11
L_retry_13:
    s_sleep 1
    s_add_u32 s96, s96, 1
    s_cmp_ge_u32 s96, 48
    s_cbranch_scc1 L_rare_14
L_back_15:
L_poll_11:
    buffer_load_dwordx4 v[80:83], v249, s[4:7], s76 offen sc1
    s_waitcnt vmcnt(0)
    v_xor_b32 v15, v80, v10
    v_bitop3_b32 v15, v15, v83, v10 bitop3:0xf6
    v_cmp_ne_u32_sdwa vcc, v15, v8 src0_sel:BYTE_0 src1_sel:DWORD
    s_cbranch_vccnz L_retry_13
L_ok_12:
    s_sleep 5
L_B_recok:
    s_mov_b32 s96, 1
    s_branch L_poll_22
L_retry_24:
    s_sleep 1
    s_add_u32 s96, s96, 1
    s_cmp_ge_u32 s96, 48
    s_cbranch_scc1 L_rare_25
L_back_26:
    s_lshr_b64 s[80:81], vcc, 4
    s_or_b64 vcc, vcc, s[80:81]
    s_lshr_b64 s[80:81], vcc, 2
    s_or_b64 vcc, vcc, s[80:81]
    s_lshr_b64 s[80:81], vcc, 1
    s_or_b64 vcc, vcc, s[80:81]
    s_and_b32 s80, vcc_lo, 0x01010101
    s_and_b32 s81, vcc_hi, 0x01010101
    s_mul_i32 exec_lo, s80, 0xff
    s_mul_i32 exec_hi, s81, 0xff
L_poll_22:
    buffer_load_dwordx2 v[84:85], v88, s[4:7], s93 offen sc1
    s_mov_b64 exec, -1
    s_waitcnt vmcnt(0)
    v_xor_b32 v15, v84, v10
    v_bitop3_b32 v15, v15, v85, v10 bitop3:0xf6
    v_cmp_ne_u32_sdwa vcc, v15, v8 src0_sel:BYTE_0 src1_sel:DWORD
    s_cbranch_vccnz L_retry_24
L_ok_23:
L_B_lnok:
    v_permlane32_swap_b32 v84, v85
    v_add_f32 v84, v84, v85
    v_mov_b32 v86, v84
    s_nop 1
    v_permlane16_swap_b32 v84, v86
    v_add_f32 v84, v84, v86
    s_nop 1
    v_add_f32_dpp v84, v84, v84 row_ror:8 row_mask:0xf bank_mask:0xf
    v_mov_b32 v85, v84
    v_mov_b32 v86, 0x3727c5ac
    s_nop 0
    v_permlane32_swap_b32 v84, v85
    v_mul_f32 v84, 0x3a800000, v84
    v_fmac_f32 v86, 0x3a800000, v85
    v_fma_f32 v86, -v84, v84, v86
    v_max_f32 v86, 0x3727c5ac, v86
    v_rsq_f32 v86, v86
    v_sub_f32 v80, v80, v84
    v_mul_f32 v80, v80, v82
    v_fma_f32 v80, v80, v86, v83
    v_cvt_pk_bf16_f32 v66, v80, 0
    s_nop 1
    v_mov_b32_dpp v16, v66 quad_perm:[0,0,0,0] row_mask:0xf bank_mask:0x3
    v_mov_b32_dpp v17, v66 quad_perm:[0,0,0,0] row_mask:0xf bank_mask:0xc
    v_mov_b32_dpp v18, v66 quad_perm:[1,1,1,1] row_mask:0xf bank_mask:0x3
    v_mov_b32_dpp v19, v66 quad_perm:[1,1,1,1] row_mask:0xf bank_mask:0xc
    v_mov_b32_dpp v20, v66 quad_perm:[2,2,2,2] row_mask:0xf bank_mask:0x3
    v_mov_b32_dpp v21, v66 quad_perm:[2,2,2,2] row_mask:0xf bank_mask:0xc
    v_mov_b32_dpp v22, v66 quad_perm:[3,3,3,3] row_mask:0xf bank_mask:0x3
    v_mov_b32_dpp v23, v66 quad_perm:[3,3,3,3] row_mask:0xf bank_mask:0xc
    v_smfmac_f32_16x16x64_bf16 v[24:27], v[16:19], v[192:199], v6
    v_smfmac_f32_16x16x64_bf16 v[28:31], v[16:19], v[200:207], v6
    v_smfmac_f32_16x16x64_bf16 v[24:27], v[20:23], v[208:215], v6
    v_smfmac_f32_16x16x64_bf16 v[28:31], v[20:23], v[216:223], v6
    buffer_store_dword v70, v69, s[4:7], s101 offen
    s_nop 5
    ds_write_b128 v12, v[24:27] offset:20480
    ds_write_b128 v12, v[28:31] offset:30720
    s_waitcnt lgkmcnt(0)
    s_barrier
    ds_read2st64_b32 v[32:33], v13 offset0:80 offset1:85
    ds_read2st64_b32 v[34:35], v13 offset0:90 offset1:95
    ds_read2st64_b32 v[36:37], v13 offset0:100 offset1:105
    ds_read2st64_b32 v[38:39], v13 offset0:110 offset1:115
    s_waitcnt lgkmcnt(2)
    v_add_f32 v32, v32, v33
    v_add_f32 v34, v34, v35
    s_waitcnt lgkmcnt(0)
    v_add_f32 v36, v36, v37
    v_add_f32 v38, v38, v39
    v_add_f32 v32, v32, v34
    v_add_f32 v36, v36, v38
    v_add_f32 v32, v32, v36
    v_and_or_b32 v32, v32, s94, v10
    buffer_store_dword v32, v14, s[4:7], s92 offen sc1
L_pub_33:
    s_barrier
    s_mov_b32 s90, 0x1000
    buffer_load_dwordx4 v[168:171], v226, s[8:11], s90 offen nt
    s_mov_b32 s90, 0x7000
    buffer_load_dwordx4 v[172:175], v226, s[8:11], s90 offen nt
    s_waitcnt vmcnt(0)
    v_mov_b32_dpp v16, v64 quad_perm:[0,0,0,0] row_mask:0xf bank_mask:0x3
    v_mov_b32_dpp v17, v64 quad_perm:[0,0,0,0] row_mask:0xf bank_mask:0xc
    v_mov_b32_dpp v18, v64 quad_perm:[1,1,1,1] row_mask:0xf bank_mask:0x3
    v_mov_b32_dpp v19, v64 quad_perm:[1,1,1,1] row_mask:0xf bank_mask:0xc
    s_nop 1
    v_smfmac_f32_16x16x64_bf16 v[76:79], v[16:19], v[168:175], v6
    s_lshl_b32 s92, s86, 10
    s_add_u32 s92, s92, s101
    s_add_u32 s92, s92, 0x28000
    s_nop 4
    ds_write_b128 v12, v[76:79] offset:40960
    s_waitcnt lgkmcnt(0)
    s_barrier
    s_cmp_ge_u32 s84, 4
    s_cbranch_scc1 L_pub_34
    ds_read2st64_b32 v[32:33], v13 offset0:160 offset1:165
    ds_read2st64_b32 v[34:35], v13 offset0:170 offset1:175
    ds_read2st64_b32 v[36:37], v13 offset0:180 offset1:185
    ds_read2st64_b32 v[38:39], v13 offset0:190 offset1:195
    s_waitcnt lgkmcnt(2)
    v_add_f32 v32, v32, v33
    v_add_f32 v34, v34, v35
    s_waitcnt lgkmcnt(0)
    v_add_f32 v36, v36, v37
    v_add_f32 v38, v38, v39
    v_add_f32 v32, v32, v34
    v_add_f32 v36, v36, v38
    v_add_f32 v32, v32, v36
    v_and_or_b32 v32, v32, s94, v10
    buffer_store_dword v32, v14, s[4:7], s92 offen
L_pub_34:
    s_barrier
    s_cmp_ge_u32 s84, 4
    s_cbranch_scc1 L_pb2_35
    s_add_u32 s92, s92, 0x30000
    buffer_store_dword v32, v14, s[4:7], s92 offen sc1
L_pb2_35:
    s_endpgm
L_B_spare:
    s_add_u32 s76, s101, 0x16000
    s_add_u32 s77, s101, 0x1e000
    buffer_load_dwordx4 v[80:83], v252, s[4:7], s76 offen offset:0 sc1
    buffer_load_dwordx4 v[84:87], v252, s[4:7], s76 offen offset:128 sc1
    buffer_load_dwordx4 v[88:91], v252, s[4:7], s77 offen offset:0 sc1
    buffer_load_dwordx4 v[92:95], v252, s[4:7], s77 offen offset:128 sc1
    s_add_u32 s76, s101, 0x26000
    s_mov_b32 s96, 1
    s_branch L_poll_36
L_retry_38:
    s_add_u32 s96, s96, 1
    s_cmp_ge_u32 s96, 48
    s_cbranch_scc1 L_rare_39
L_back_40:
L_poll_36:
    buffer_load_dwordx4 v[96:99], v253, s[4:7], s76 offen sc1
    buffer_load_dwordx4 v[100:103], v253, s[4:7], s76 offen offset:1024 sc1
    s_waitcnt vmcnt(1)
    v_xor_b32 v15, v96, v70
    v_bitop3_b32 v15, v15, v99, v70 bitop3:0xf6
    s_waitcnt vmcnt(0)
    v_bitop3_b32 v15, v15, v100, v70 bitop3:0xf6
    v_bitop3_b32 v15, v15, v103, v70 bitop3:0xf6
    v_cmp_ne_u32 vcc, 0, v15
    s_cbranch_vccnz L_retry_38
L_ok_37:
    v_xor_b32 v15, v80, v10
    v_bitop3_b32 v15, v15, v83, v10 bitop3:0xf6
    v_bitop3_b32 v15, v15, v84, v10 bitop3:0xf6
    v_bitop3_b32 v15, v15, v87, v10 bitop3:0xf6
    v_bitop3_b32 v15, v15, v88, v10 bitop3:0xf6
    v_bitop3_b32 v15, v15, v91, v10 bitop3:0xf6
    v_bitop3_b32 v15, v15, v92, v10 bitop3:0xf6
    v_bitop3_b32 v15, v15, v95, v10 bitop3:0xf6
    v_cmp_ne_u32_sdwa vcc, v15, v8 src0_sel:BYTE_0 src1_sel:DWORD
    s_or_b32 vcc_lo, vcc_lo, 1
    s_add_u32 s76, s101, 0x16000
    s_add_u32 s77, s101, 0x1e000
    s_mov_b32 s96, 1
    s_branch L_back_50
L_retry_48:
    s_add_u32 s96, s96, 1
    s_cmp_ge_u32 s96, 48
    s_cbranch_scc1 L_rare_49
L_back_50:
    s_lshr_b64 s[80:81], vcc, 4
    s_or_b64 vcc, vcc, s[80:81]
    s_lshr_b64 s[80:81], vcc, 2
    s_or_b64 vcc, vcc, s[80:81]
    s_lshr_b64 s[80:81], vcc, 1
    s_or_b64 vcc, vcc, s[80:81]
    s_and_b32 s80, vcc_lo, 0x01010101
    s_and_b32 s81, vcc_hi, 0x01010101
    s_mul_i32 exec_lo, s80, 0xff
    s_mul_i32 exec_hi, s81, 0xff
L_poll_46:
    buffer_load_dwordx4 v[80:83], v252, s[4:7], s76 offen sc1
    buffer_load_dwordx4 v[84:87], v252, s[4:7], s76 offen offset:128 sc1
    buffer_load_dwordx4 v[88:91], v252, s[4:7], s77 offen sc1
    buffer_load_dwordx4 v[92:95], v252, s[4:7], s77 offen offset:128 sc1
    s_mov_b64 exec, -1
    v_max_f32 v104, v97, v101
    s_nop 1
    v_max_f32_dpp v104, v104, v104 row_ror:8 row_mask:0xf bank_mask:0xf
    v_mov_b32 v105, v104
    s_nop 1
    v_permlane16_swap_b32 v104, v105
    v_max_f32 v104, v104, v105
    v_mov_b32 v105, v104
    s_nop 1
    v_permlane32_swap_b32 v104, v105
    v_max_f32 v104, v104, v105
    v_sub_f32 v106, v97, v104
    v_sub_f32 v108, v101, v104
    v_exp_f32 v106, v106
    v_exp_f32 v108, v108
    v_mul_f32 v104, v106, v98
    v_fmac_f32 v104, v108, v102
    s_nop 1
    v_add_f32_dpp v104, v104, v104 row_ror:8 row_mask:0xf bank_mask:0xf
    v_mov_b32 v105, v104
    s_nop 1
    v_permlane16_swap_b32 v104, v105
    v_add_f32 v104, v104, v105
    v_mov_b32 v105, v104
    s_nop 1
    v_permlane32_swap_b32 v104, v105
    v_add_f32 v104, v104, v105
    v_rcp_f32 v104, v104
    s_nop 0
    v_mul_f32 v106, v106, v104
    v_mul_f32 v108, v108, v104
    s_waitcnt vmcnt(3)
    v_xor_b32 v15, v80, v10
    v_bitop3_b32 v15, v15, v83, v10 bitop3:0xf6
    v_pk_mul_f32 v[112:113], v[80:81], v[106:107] op_sel_hi:[1,0]
    v_pk_mul_f32 v[114:115], v[82:83], v[106:107] op_sel_hi:[1,0]
    s_waitcnt vmcnt(2)
    v_bitop3_b32 v15, v15, v84, v10 bitop3:0xf6
    v_bitop3_b32 v15, v15, v87, v10 bitop3:0xf6
    v_pk_mul_f32 v[116:117], v[84:85], v[106:107] op_sel_hi:[1,0]
    v_pk_mul_f32 v[118:119], v[86:87], v[106:107] op_sel_hi:[1,0]
    s_waitcnt vmcnt(1)
    v_bitop3_b32 v15, v15, v88, v10 bitop3:0xf6
    v_bitop3_b32 v15, v15, v91, v10 bitop3:0xf6
    v_pk_fma_f32 v[112:113], v[88:89], v[108:109], v[112:113] op_sel_hi:[1,0,1]
    v_pk_fma_f32 v[114:115], v[90:91], v[108:109], v[114:115] op_sel_hi:[1,0,1]
    s_waitcnt vmcnt(0)
    v_bitop3_b32 v15, v15, v92, v10 bitop3:0xf6
    v_bitop3_b32 v15, v15, v95, v10 bitop3:0xf6
    v_cmp_ne_u32_sdwa vcc, v15, v8 src0_sel:BYTE_0 src1_sel:DWORD
    s_cbranch_vccnz L_retry_48
L_ok_47:
    v_pk_fma_f32 v[116:117], v[92:93], v[108:109], v[116:117] op_sel_hi:[1,0,1]
    v_pk_fma_f32 v[118:119], v[94:95], v[108:109], v[118:119] op_sel_hi:[1,0,1]
    v_permlane32_swap_b32 v112, v114
    v_permlane32_swap_b32 v113, v115
    v_permlane32_swap_b32 v116, v118
    v_permlane32_swap_b32 v117, v119
    v_add_f32 v112, v112, v114
    v_add_f32 v113, v113, v115
    v_add_f32 v116, v116, v118
    v_add_f32 v117, v117, v119
    v_permlane16_swap_b32 v112, v113
    s_nop 0
    v_permlane16_swap_b32 v116, v117
    v_add_f32 v112, v112, v113
    v_add_f32 v116, v116, v117
    s_nop 0
    v_add_f32_dpp v112, v112, v112 row_ror:8 row_mask:0xf bank_mask:0xf
    v_add_f32_dpp v116, v116, v116 row_ror:8 row_mask:0xf bank_mask:0xf
    v_cvt_pk_bf16_f32 v112, 0, v112
    v_cvt_pk_bf16_f32 v116, 0, v116
    v_or_b32 v112, v112, v10
    v_or_b32 v116, v116, v10
    buffer_store_dword v112, v254, s[4:7], s100 offen offset:0 sc1
    buffer_store_dword v116, v254, s[4:7], s100 offen offset:128 sc1
    s_barrier
    s_cmp_eq_u32 s86, 14
    s_cbranch_scc1 L_B_ln
    s_add_u32 s76, s101, 0x2c000
    s_add_u32 s77, s101, 0x2e000
    s_add_u32 s78, s101, 0x8000
    s_add_u32 s79, s101, 0xa000
    s_mov_b32 s96, 1
    s_branch L_poll_56
L_retry_58:
    s_sleep 1
    s_add_u32 s96, s96, 1
    s_cmp_ge_u32 s96, 48
    s_cbranch_scc1 L_rare_59
L_back_60:
L_poll_56:
    buffer_load_dwordx4 v[80:83], v11, s[4:7], s76 offen sc1
    buffer_load_dwordx4 v[84:87], v11, s[4:7], s77 offen sc1
    buffer_load_dwordx4 v[88:91], v11, s[4:7], s78 offen sc1
    buffer_load_dwordx4 v[92:95], v11, s[4:7], s79 offen sc1
    s_waitcnt vmcnt(3)
    v_xor_b32 v15, v80, v10
    v_bitop3_b32 v15, v15, v83, v10 bitop3:0xf6
    s_waitcnt vmcnt(2)
    v_bitop3_b32 v15, v15, v84, v10 bitop3:0xf6
    v_bitop3_b32 v15, v15, v87, v10 bitop3:0xf6
    s_waitcnt vmcnt(1)
    v_bitop3_b32 v15, v15, v88, v10 bitop3:0xf6
    v_bitop3_b32 v15, v15, v91, v10 bitop3:0xf6
    s_waitcnt vmcnt(0)
    v_bitop3_b32 v15, v15, v92, v10 bitop3:0xf6
    v_bitop3_b32 v15, v15, v95, v10 bitop3:0xf6
    v_cmp_ne_u32_sdwa vcc, v15, v8 src0_sel:BYTE_0 src1_sel:DWORD
    s_cbranch_vccnz L_retry_58
L_ok_57:
    v_add_f32 v88, v88, v92
    v_add_f32 v80, v80, v84
    v_add_f32 v89, v89, v93
    v_add_f32 v81, v81, v85
    v_add_f32 v90, v90, v94
    v_add_f32 v82, v82, v86
    v_add_f32 v91, v91, v95
    v_add_f32 v83, v83, v87
    v_permlane32_swap_b32 v80, v82
    s_nop 0
    v_permlane32_swap_b32 v81, v83
    v_permlane32_swap_b32 v88, v90
    v_permlane32_swap_b32 v89, v91
    v_add_f32 v80, v80, v82
    v_add_f32 v81, v81, v83
    v_add_f32 v88, v88, v90
    v_add_f32 v89, v89, v91
    v_permlane16_swap_b32 v80, v81
    s_nop 0
    v_permlane16_swap_b32 v88, v89
    v_add_f32 v80, v80, v81
    v_add_f32 v88, v88, v89
    s_nop 0
    v_add_f32_dpp v80, v80, v80 row_ror:8 row_mask:0xf bank_mask:0xf
    v_add_f32_dpp v88, v88, v88 row_ror:8 row_mask:0xf bank_mask:0xf
    v_add_f32 v88, 1.0, v88
    v_and_or_b32 v89, v80, s94, v10
    v_and_or_b32 v88, v88, s94, v10
    s_add_u32 s92, s101, 0x26800
    buffer_store_dwordx2 v[88:89], v249, s[4:7], s92 offen offset:8
    s_barrier
    s_add_u32 s92, s92, 0x30000
    buffer_store_dwordx2 v[88:89], v249, s[4:7], s92 offen offset:8 sc1
    s_lshl_b32 s91, s84, 5
    s_add_u32 s91, s91, 1536
    buffer_load_ushort v234, v5, s[40:43], s91 offen
    v_subrev_u32 v227, 1572864, v226
    s_mov_b32 s90, 0x1000
    buffer_load_dwordx4 v[168:171], v226, s[8:11], s90 offen nt
    s_mov_b32 s90, 0x7000
    buffer_load_dwordx4 v[172:175], v226, s[8:11], s90 offen nt
    s_mov_b32 s90, 0x1000
    buffer_load_dwordx4 v[200:203], v227, s[8:11], s90 offen nt
    s_mov_b32 s90, 0x7000
    buffer_load_dwordx4 v[204:207], v227, s[8:11], s90 offen nt
    s_waitcnt vmcnt(4)
    v_lshlrev_b32 v40, 16, v234
    v_mul_f32 v41, 0xbfb8aa3b, v40
    v_exp_f32 v41, v41
    s_nop 0
    v_add_f32 v41, 1.0, v41
    v_rcp_f32 v42, v41
    s_nop 0
    v_mul_f32 v43, v40, v42
    v_cvt_pk_bf16_f32 v65, v43, 0
    s_nop 1
    v_mov_b32_dpp v65, v65 quad_perm:[2,3,2,3] row_mask:0xf bank_mask:0xf
    s_waitcnt vmcnt(0)
    s_nop 0
    v_mov_b32_dpp v16, v65 quad_perm:[0,0,0,0] row_mask:0xf bank_mask:0x3
    v_mov_b32_dpp v17, v65 quad_perm:[0,0,0,0] row_mask:0xf bank_mask:0xc
    v_mov_b32_dpp v18, v65 quad_perm:[1,1,1,1] row_mask:0xf bank_mask:0x3
    v_mov_b32_dpp v19, v65 quad_perm:[1,1,1,1] row_mask:0xf bank_mask:0xc
    s_nop 1
    v_smfmac_f32_16x16x64_bf16 v[72:75], v[16:19], v[200:207], v6
    v_mov_b32_dpp v16, v64 quad_perm:[0,0,0,0] row_mask:0xf bank_mask:0x3
    v_mov_b32_dpp v17, v64 quad_perm:[0,0,0,0] row_mask:0xf bank_mask:0xc
    v_mov_b32_dpp v18, v64 quad_perm:[1,1,1,1] row_mask:0xf bank_mask:0x3
    v_mov_b32_dpp v19, v64 quad_perm:[1,1,1,1] row_mask:0xf bank_mask:0xc
    s_nop 1
    v_smfmac_f32_16x16x64_bf16 v[76:79], v[16:19], v[168:175], v6
    s_add_u32 s92, s101, 0x2b800
    s_lshr_b32 s90, s84, 2
    s_mul_i32 s90, s90, 1024
    s_add_u32 s92, s92, s90
    ds_write_b128 v12, v[72:75] offset:0
    s_nop 2
    ds_write_b128 v12, v[76:79] offset:10240
    s_waitcnt lgkmcnt(0)
    s_barrier
    ds_read2st64_b32 v[32:33], v13 offset0:0 offset1:5
    ds_read2st64_b32 v[34:35], v13 offset0:10 offset1:15
    ds_read2st64_b32 v[36:37], v13 offset0:20 offset1:25
    ds_read2st64_b32 v[38:39], v13 offset0:30 offset1:35
    s_waitcnt lgkmcnt(2)
    v_add_f32 v32, v32, v33
    v_add_f32 v34, v34, v35
    s_waitcnt lgkmcnt(0)
    v_add_f32 v36, v36, v37
    v_add_f32 v38, v38, v39
    v_add_f32 v32, v32, v34
    v_add_f32 v36, v36, v38
    v_add_f32 v32, v32, v36
    v_and_or_b32 v32, v32, s94, v10
    buffer_store_dword v32, v14, s[4:7], s92 offen
L_pub_66:
    s_barrier
    s_add_u32 s92, s92, 0x30000
    buffer_store_dword v32, v14, s[4:7], s92 offen sc1
L_pb2_67:
    s_add_u32 s76, s101, 0x26800
    s_mov_b32 s96, 1
    s_branch L_poll_68
L_retry_70:
    s_sleep 4
    s_add_u32 s96, s96, 1
    s_cmp_ge_u32 s96, 48
    s_cbranch_scc1 L_rare_71
L_back_72:
L_poll_68:
    buffer_load_dwordx4 v[96:99], v249, s[4:7], s76 offen sc1
    s_waitcnt vmcnt(0)
    v_xor_b32 v15, v96, v10
    v_bitop3_b32 v15, v15, v99, v10 bitop3:0xf6
    v_cmp_ne_u32_sdwa vcc, v15, v8 src0_sel:BYTE_0 src1_sel:DWORD
    s_cbranch_vccnz L_retry_70
L_ok_69:
    s_endpgm
L_B_ln:
    s_lshl_b32 s91, s84, 5
    s_lshl_b32 s90, s85, 8
    s_add_u32 s90, s90, s91
    buffer_load_ushort v233, v5, s[36:39], s90 offen
    s_waitcnt vmcnt(0)
    v_lshlrev_b32 v96, 16, v233
    s_lshl_b32 s90, s84, 3
    s_add_u32 s90, s90, 148224
    v_lshl_add_u32 v100, v4, 6, s90
    v_lshrrev_b32 v32, 5, v1
    v_lshl_add_u32 v100, v32, 2, v100
    v_and_b32 v101, 0x38, v1
    v_lshl_add_u32 v101, v4, 6, v101
    v_add_u32 v101, 148224, v101
    v_bfe_u32 v102, v1, 3, 2
    v_and_b32 v15, 1, v1
    v_lshl_add_u32 v102, v15, 2, v102
    v_lshlrev_b32 v102, 10, v102
    v_lshl_add_u32 v102, v4, 3, v102
    v_lshl_add_u32 v102, v32, 2, v102
    v_lshrrev_b32 v103, 3, v1
    v_lshlrev_b32 v103, 10, v103
    v_and_b32 v15, 7, v1
    v_lshl_add_u32 v103, v15, 4, v103
    s_lshl_b32 s92, s85, 7
    s_add_u32 s92, s92, 0x49000
    s_lshl_b32 s93, s84, 14
    s_add_u32 s92, s92, s93
    s_lshl_b32 s93, s85, 10
    s_add_u32 s93, s93, 0x49000
    s_add_u32 s100, s101, 0x26800
    s_lshl_b32 s91, s85, 8
    s_lshl_b32 s90, s84, 5
    s_add_u32 s91, s91, s90
    v_mov_b32 v105, v70
    s_add_u32 s76, s101, 0x4000
    s_add_u32 s77, s101, 0x6000
    s_mov_b32 s96, 1
    s_branch L_poll_77
L_retry_79:
    s_sleep 1
    s_add_u32 s96, s96, 1
    s_cmp_ge_u32 s96, 48
    s_cbranch_scc1 L_rare_80
L_back_81:
L_poll_77:
    buffer_load_dwordx4 v[80:83], v11, s[4:7], s76 offen sc1
    buffer_load_dwordx4 v[84:87], v11, s[4:7], s77 offen sc1
    s_waitcnt vmcnt(1)
    v_xor_b32 v15, v80, v10
    v_bitop3_b32 v15, v15, v83, v10 bitop3:0xf6
    s_waitcnt vmcnt(0)
    v_bitop3_b32 v15, v15, v84, v10 bitop3:0xf6
    v_bitop3_b32 v15, v15, v87, v10 bitop3:0xf6
    v_cmp_ne_u32_sdwa vcc, v15, v8 src0_sel:BYTE_0 src1_sel:DWORD
    s_cbranch_vccnz L_retry_79
L_ok_78:
    v_add_f32 v80, v80, v84
    v_add_f32 v81, v81, v85
    v_add_f32 v82, v82, v86
    v_add_f32 v83, v83, v87
    s_nop 0
    v_permlane32_swap_b32 v80, v82
    v_permlane32_swap_b32 v81, v83
    v_add_f32 v80, v80, v82
    v_add_f32 v81, v81, v83
    s_nop 1
    v_permlane16_swap_b32 v80, v81
    v_add_f32 v80, v80, v81
    s_nop 1
    v_add_f32_dpp v80, v80, v80 row_ror:8 row_mask:0xf bank_mask:0xf
    s_add_u32 s76, s101, 0xc000
    s_add_u32 s77, s101, 0xe000
    s_mov_b32 s96, 1
    s_branch L_poll_87
L_retry_89:
    s_add_u32 s96, s96, 1
    s_cmp_ge_u32 s96, 48
    s_cbranch_scc1 L_rare_90
L_back_91:
L_poll_87:
    buffer_load_dwordx4 v[32:35], v11, s[4:7], s76 offen sc1
    buffer_load_dwordx4 v[36:39], v11, s[4:7], s77 offen sc1
    s_waitcnt vmcnt(1)
    v_xor_b32 v15, v32, v10
    v_bitop3_b32 v15, v15, v35, v10 bitop3:0xf6
    s_waitcnt vmcnt(0)
    v_bitop3_b32 v15, v15, v36, v10 bitop3:0xf6
    v_bitop3_b32 v15, v15, v39, v10 bitop3:0xf6
    v_cmp_ne_u32_sdwa vcc, v15, v8 src0_sel:BYTE_0 src1_sel:DWORD
    s_cbranch_vccnz L_retry_89
L_ok_88:
    v_add_f32 v32, v32, v36
    v_add_f32 v33, v33, v37
    v_add_f32 v34, v34, v38
    v_add_f32 v35, v35, v39
    s_nop 0
    v_permlane32_swap_b32 v32, v34
    v_permlane32_swap_b32 v33, v35
    v_add_f32 v32, v32, v34
    v_add_f32 v33, v33, v35
    s_nop 1
    v_permlane16_swap_b32 v32, v33
    v_add_f32 v32, v32, v33
    s_nop 1
    v_add_f32_dpp v32, v32, v32 row_ror:8 row_mask:0xf bank_mask:0xf
    v_fmac_f32 v96, v32, v80
    v_mov_b32 v32, v96
    v_mul_f32 v33, v96, v96
    v_and_or_b32 v104, v96, s94, v10
    s_nop 0
    v_permlane32_swap_b32 v32, v33
    v_add_f32 v32, v32, v33
    v_mov_b32 v33, v32
    s_nop 1
    v_permlane16_swap_b32 v32, v33
    v_add_f32 v32, v32, v33
    s_nop 1
    v_add_f32_dpp v32, v32, v32 quad_perm:[1,0,3,2] row_mask:0xf bank_mask:0xf
    s_nop 1
    v_add_f32_dpp v32, v32, v32 quad_perm:[2,3,0,1] row_mask:0xf bank_mask:0xf
    ds_write_b32 v100, v32
    buffer_store_dwordx2 v[104:105], v249, s[4:7], s100 offen
    s_waitcnt lgkmcnt(0)
    s_barrier
    s_cmp_ge_u32 s84, 1
    s_cbranch_scc1 L_B_nostat
    ds_read_b64 v[40:41], v101
    s_waitcnt lgkmcnt(0)
    v_permlane32_swap_b32 v40, v41
    v_add_f32 v40, v40, v41
    v_mov_b32 v42, v40
    s_nop 1
    v_permlane16_swap_b32 v40, v42
    v_add_f32 v40, v40, v42
    s_nop 1
    v_add_f32_dpp v40, v40, v40 row_ror:8 row_mask:0xf bank_mask:0xf
    v_and_or_b32 v40, v40, s94, v10
    v_mov_b32 v41, v40
    s_nop 1
    v_permlane32_swap_b32 v40, v41
    v_mov_b32 v42, v40
    v_mov_b32 v43, v41
    s_nop 0
    v_mov_b32_dpp v42, v40 row_shl:4 row_mask:0xf bank_mask:0x5
    v_mov_b32_dpp v43, v41 row_shl:4 row_mask:0xf bank_mask:0x5
    v_mov_b32_dpp v40, v40 row_shr:4 row_mask:0xf bank_mask:0xa
    v_mov_b32_dpp v41, v41 row_shr:4 row_mask:0xf bank_mask:0xa
    buffer_store_dwordx4 v[40:43], v103, s[4:7], s92 offen sc1
L_B_nostat:
    s_barrier
    s_add_u32 s100, s100, 0x30000
    buffer_store_dwordx2 v[104:105], v249, s[4:7], s100 offen sc1
    s_or_b32 s90, s85, s84
    s_cmp_lg_u32 s90, 0
    s_cbranch_scc1 L_B_done
    s_mov_b64 exec, 1
    buffer_store_dword v70, v1, s[4:7], 0 offen sc1
    s_mov_b64 exec, -1
L_B_done:
    s_add_u32 s90, s101, 0x10000
    v_min_u32 v15, 127, v0
    v_lshlrev_b32 v15, 7, v15
    buffer_load_dword v251, v15, s[4:7], s90 offen sc1
    s_add_u32 s76, s101, 0x28000
    s_add_u32 s77, s101, 0x2a000
    s_mov_b32 s96, 1
    s_branch L_poll_97
L_retry_99:
    s_sleep 1
    s_add_u32 s96, s96, 1
    s_cmp_ge_u32 s96, 48
    s_cbranch_scc1 L_rare_100
L_back_101:
L_poll_97:
    buffer_load_dwordx4 v[108:111], v11, s[4:7], s76 offen sc1
    buffer_load_dwordx4 v[112:115], v11, s[4:7], s77 offen sc1
    s_waitcnt vmcnt(1)
    v_xor_b32 v15, v108, v10
    v_bitop3_b32 v15, v15, v111, v10 bitop3:0xf6
    s_waitcnt vmcnt(0)
    v_bitop3_b32 v15, v15, v112, v10 bitop3:0xf6
    v_bitop3_b32 v15, v15, v115, v10 bitop3:0xf6
    v_cmp_ne_u32_sdwa vcc, v15, v8 src0_sel:BYTE_0 src1_sel:DWORD
    s_cbranch_vccnz L_retry_99
L_ok_98:
    v_add_f32 v108, v108, v112
    v_add_f32 v109, v109, v113
    v_add_f32 v110, v110, v114
    v_add_f32 v111, v111, v115
    s_nop 0
    v_permlane32_swap_b32 v108, v110
    v_permlane32_swap_b32 v109, v111
    v_add_f32 v108, v108, v110
    v_add_f32 v109, v109, v111
    s_nop 1
    v_permlane16_swap_b32 v108, v109
    v_add_f32 v108, v108, v109
    s_nop 1
    v_add_f32_dpp v108, v108, v108 row_ror:8 row_mask:0xf bank_mask:0xf
    s_add_u32 s76, s101, 0x10000
    s_add_u32 s77, s101, 0x12000
    s_mov_b32 s96, 1
    s_branch L_poll_102
L_retry_104:
    s_add_u32 s96, s96, 1
    s_cmp_ge_u32 s96, 48
    s_cbranch_scc1 L_rare_105
L_back_106:
L_poll_102:
    buffer_load_dwordx4 v[32:35], v11, s[4:7], s76 offen sc1
    buffer_load_dwordx4 v[36:39], v11, s[4:7], s77 offen sc1
    s_waitcnt vmcnt(1)
    v_xor_b32 v15, v32, v10
    v_bitop3_b32 v15, v15, v35, v10 bitop3:0xf6
    s_waitcnt vmcnt(0)
    v_bitop3_b32 v15, v15, v36, v10 bitop3:0xf6
    v_bitop3_b32 v15, v15, v39, v10 bitop3:0xf6
    v_cmp_ne_u32_sdwa vcc, v15, v8 src0_sel:BYTE_0 src1_sel:DWORD
    s_cbranch_vccnz L_retry_104
L_ok_103:
    v_add_f32 v32, v32, v36
    v_add_f32 v33, v33, v37
    v_add_f32 v34, v34, v38
    v_add_f32 v35, v35, v39
    s_nop 0
    v_permlane32_swap_b32 v32, v34
    v_permlane32_swap_b32 v33, v35
    v_add_f32 v32, v32, v34
    v_add_f32 v33, v33, v35
    s_nop 1
    v_permlane16_swap_b32 v32, v33
    v_add_f32 v32, v32, v33
    s_nop 1
    v_add_f32_dpp v32, v32, v32 row_ror:8 row_mask:0xf bank_mask:0xf
    v_fmac_f32 v96, v32, v108
    v_cvt_pk_bf16_f32 v32, v96, v96
    s_mov_b32 exec_lo, 0x00ff00ff
    s_mov_b32 exec_hi, 0x00ff00ff
    buffer_store_short v32, v5, s[44:47], s91 offen
    s_mov_b64 exec, -1
    s_endpgm
L_progA:
    s_load_dwordx2 s[16:17], s[0:1], 16
    s_mov_b32 s18, 0x4000000
    s_mov_b32 s19, 0x20000
    s_mov_b32 s94, 0xffffff00
    s_mov_b32 s95, 0xffff0000
    s_mov_b32 s97, 0
    s_mov_b32 s6, 0x800000
    s_mov_b32 s7, 0x20000
    s_mov_b32 s26, 0x800000
    s_mov_b32 s27, 0x20000
    s_mov_b32 s34, 0x700000
    s_mov_b32 s35, 0x20000
    s_mul_i32 s101, s85, 0x60000
    s_add_u32 s101, s101, 0x80000
    s_mov_b32 s10, 0xc00000
    s_mov_b32 s11, 0x20000
    s_mov_b32 s42, 0x1000
    s_mov_b32 s43, 0x20000
    v_and_b32 v6, 3, v1
    v_mul_u32_u24 v6, 0x5555, v6
    v_mov_b32 v16, 0
    v_mov_b32 v17, 0
    v_mov_b32 v18, 0
    v_mov_b32 v19, 0
    v_mov_b32 v20, 0
    v_mov_b32 v21, 0
    v_mov_b32 v22, 0
    v_mov_b32 v23, 0
    v_mov_b32 v8, 0
    v_lshrrev_b32 v11, 3, v1
    v_lshlrev_b32 v11, 10, v11
    v_and_b32 v15, 7, v1
    v_lshl_add_u32 v11, v15, 4, v11
    s_lshl_b32 s90, s84, 7
    v_add_u32 v11, s90, v11
    s_mul_i32 s90, s84, 1280
    v_mul_u32_u24 v12, 288, v2
    v_lshl_add_u32 v12, v3, 4, v12
    v_add_u32 v12, s90, v12
    s_and_b32 s90, s84, 3
    s_lshl_b32 s90, s90, 6
    v_add_u32 v32, s90, v1
    v_lshlrev_b32 v14, 2, v32
    s_lshr_b32 s90, s84, 2
    s_mul_i32 s90, s90, 10240
    v_and_b32 v33, 3, v32
    v_lshl_add_u32 v33, v33, 2, s90
    v_bfe_u32 v34, v32, 2, 1
    v_bfe_u32 v35, v32, 4, 1
    v_lshl_add_u32 v35, v34, 1, v35
    v_mul_u32_u24 v13, 288, v35
    v_lshrrev_b32 v35, 5, v32
    v_bfe_u32 v36, v32, 3, 1
    v_lshl_add_u32 v35, v35, 1, v36
    v_lshl_add_u32 v13, v35, 4, v13
    v_add_u32 v13, v13, v33
    v_lshrrev_b32 v35, 7, v32
    v_lshl_add_u32 v35, v34, 1, v35
    v_mul_u32_u24 v68, 288, v35
    v_bfe_u32 v35, v32, 3, 4
    v_lshl_add_u32 v68, v35, 4, v68
    v_add_u32 v68, v68, v33
    s_waitcnt lgkmcnt(0)
    s_add_u32 s87, s87, 1
    s_and_b32 s90, s87, 0xff
    v_mov_b32 v10, s90
    v_mov_b32 v70, s87
    s_and_b32 s92, s86, 7
    s_lshl_b32 s92, s92, 7
    s_lshl_b32 s91, s84, 4
    s_add_u32 s92, s92, s91
    s_and_b32 s91, s86, 8
    s_add_u32 s91, s91, s85
    s_add_u32 s91, s91, 16
    s_lshl_b32 s91, s91, 8
    s_mul_i32 s92, s92, 12288
    s_add_u32 s92, s92, s91
    v_mul_u32_u24 v210, 12288, v7
    v_lshl_add_u32 v210, v3, 4, v210
    v_add_u32 v210, s92, v210
    s_and_b32 s90, s86, 8
    s_mul_i32 s90, s90, 12032
    v_add_u32 v210, s90, v210
    s_lshl_b32 s92, s86, 8
    s_lshl_b32 s91, s84, 5
    s_add_u32 s92, s92, s91
    s_lshl_b32 s91, s85, 8
    s_mul_i32 s92, s92, 2048
    s_add_u32 s92, s92, s91
    v_mul_u32_u24 v212, 2048, v7
    v_lshl_add_u32 v212, v3, 4, v212
    v_add_u32 v212, s92, v212
    s_waitcnt vmcnt(5)
    s_mov_b32 s90, 0x3f803f80
    v_dot2_f32_bf16 v32, v218, s90, 0
    v_dot2_f32_bf16 v33, v218, v218, 0
    v_dot2_f32_bf16 v32, v219, s90, v32
    v_dot2_f32_bf16 v33, v219, v219, v33
    s_nop 1
    v_add_f32_dpp v32, v32, v32 quad_perm:[1,0,3,2] row_mask:0xf bank_mask:0xf
    v_add_f32_dpp v33, v33, v33 quad_perm:[1,0,3,2] row_mask:0xf bank_mask:0xf
    s_nop 0
    v_add_f32_dpp v32, v32, v32 quad_perm:[2,3,0,1] row_mask:0xf bank_mask:0xf
    v_add_f32_dpp v33, v33, v33 quad_perm:[2,3,0,1] row_mask:0xf bank_mask:0xf
    s_nop 0
    v_add_f32_dpp v32, v32, v32 row_half_mirror row_mask:0xf bank_mask:0xf
    v_add_f32_dpp v33, v33, v33 row_half_mirror row_mask:0xf bank_mask:0xf
    s_nop 0
    v_add_f32_dpp v32, v32, v32 row_mirror row_mask:0xf bank_mask:0xf
    v_add_f32_dpp v33, v33, v33 row_mirror row_mask:0xf bank_mask:0xf
    s_lshl_b32 s90, s84, 5
    s_add_u32 s90, s90, 141312
    v_lshl_add_u32 v15, v2, 3, s90
    ds_write_b64 v15, v[32:33]
    s_lshl_b32 s91, s84, 5
    s_and_b32 s90, s86, 7
    s_lshl_b32 s90, s90, 8
    s_add_u32 s90, s90, s91
    buffer_load_ushort v216, v5, s[40:43], s90 offen
    s_waitcnt lgkmcnt(0)
    s_barrier
    v_lshrrev_b32 v15, 3, v1
    v_lshlrev_b32 v15, 5, v15
    v_lshl_add_u32 v15, v4, 4, v15
    v_add_u32 v15, 141312, v15
    ds_read_b128 v[32:35], v15
    s_waitcnt lgkmcnt(0)
    v_add_f32 v32, v32, v34
    v_add_f32 v33, v33, v35
    s_nop 1
    v_permlane32_swap_b32 v32, v33
    v_add_f32 v32, v32, v33
    v_mov_b32 v34, v32
    s_nop 1
    v_permlane16_swap_b32 v32, v34
    v_add_f32 v32, v32, v34
    s_nop 1
    v_add_f32_dpp v32, v32, v32 row_ror:8 row_mask:0xf bank_mask:0xf
    v_mov_b32 v33, v32
    s_nop 1
    v_permlane32_swap_b32 v32, v33
    v_mul_f32 v32, 0x3a800000, v32
    v_mul_f32 v33, 0x3a800000, v33
    v_fma_f32 v33, -v32, v32, v33
    v_max_f32 v33, 0, v33
    v_cvt_pk_bf16_f32 v34, v32, v33
    v_lshlrev_b32 v32, 16, v34
    v_and_b32 v33, s95, v34
    v_add_f32 v33, 0x3727c5ac, v33
    v_cvt_pk_bf16_f32 v33, v33, v33
    v_and_b32 v33, s95, v33
    v_sqrt_f32 v33, v33
    s_nop 0
    v_cvt_pk_bf16_f32 v33, v33, v33
    v_and_b32 v33, s95, v33
    v_lshlrev_b32 v220, 16, v232
    v_sub_f32 v220, v220, v32
    v_cvt_pk_bf16_f32 v220, v220, v220
    v_and_b32 v220, s95, v220
    v_rcp_f32 v36, v33
    s_nop 0
    v_mul_f32 v37, v220, v36
    v_fma_f32 v38, -v37, v33, v220
    v_fma_f32 v220, v38, v36, v37
    v_cvt_pk_bf16_f32 v220, v220, v220
    v_and_b32 v220, s95, v220
    s_lshl_b32 s92, s86, 4
    s_add_u32 s92, s92, s85
    s_lshl_b32 s92, s92, 10
    s_add_u32 s92, s92, 0x1000
    s_lshr_b32 s90, s84, 2
    s_mul_i32 s90, s90, 8192
    s_add_u32 s92, s92, s90
    v_mov_b32 v24, 0
    v_mov_b32 v25, 0
    v_mov_b32 v26, 0
    v_mov_b32 v27, 0
    v_mov_b32 v28, 0
    v_mov_b32 v29, 0
    v_mov_b32 v30, 0
    v_mov_b32 v31, 0
    v_mov_b32 v72, 0
    v_mov_b32 v73, 0
    v_mov_b32 v74, 0
    v_mov_b32 v75, 0
    s_lshr_b32 s90, s84, 2
    s_mul_i32 s90, s90, 10240
    v_and_b32 v9, 1, v1
    v_lshrrev_b32 v15, 5, v1
    v_lshl_add_u32 v9, v9, 1, v15
    v_mul_u32_u24 v9, 288, v9
    v_bfe_u32 v15, v1, 1, 4
    v_lshl_add_u32 v9, v15, 4, v9
    v_add_u32 v9, s90, v9
    s_add_u32 s76, s101, 0x0
    s_add_u32 s77, s101, 0x2000
    s_mov_b32 s96, 1
    s_branch L_poll_107
L_retry_109:
    s_sleep 1
    s_add_u32 s96, s96, 1
    s_cmp_ge_u32 s96, 48
    s_cbranch_scc1 L_rare_110
L_back_111:
L_poll_107:
    buffer_load_dwordx4 v[32:35], v11, s[4:7], s76 offen sc1
    buffer_load_dwordx4 v[36:39], v11, s[4:7], s77 offen sc1
    s_waitcnt vmcnt(1)
    v_xor_b32 v15, v32, v10
    v_bitop3_b32 v15, v15, v35, v10 bitop3:0xf6
    s_waitcnt vmcnt(0)
    v_bitop3_b32 v15, v15, v36, v10 bitop3:0xf6
    v_bitop3_b32 v15, v15, v39, v10 bitop3:0xf6
    v_cmp_ne_u32_sdwa vcc, v15, v8 src0_sel:BYTE_0 src1_sel:DWORD
    s_cbranch_vccnz L_retry_109
L_ok_108:
    v_permlane32_swap_b32 v32, v34
    v_permlane32_swap_b32 v33, v35
    v_permlane32_swap_b32 v36, v38
    v_permlane32_swap_b32 v37, v39
    v_add_f32 v32, v32, v34
    v_add_f32 v33, v33, v35
    v_add_f32 v36, v36, v38
    v_add_f32 v37, v37, v39
    v_permlane16_swap_b32 v32, v33
    s_nop 0
    v_permlane16_swap_b32 v36, v37
    v_add_f32 v32, v32, v33
    v_add_f32 v36, v36, v37
    s_nop 0
    v_add_f32_dpp v32, v32, v32 row_ror:8 row_mask:0xf bank_mask:0xf
    v_add_f32_dpp v36, v36, v36 row_ror:8 row_mask:0xf bank_mask:0xf
    v_add_f32 v32, v32, v220
    v_fmac_f32 v32, v36, v220
    v_cvt_pk_bf16_f32 v66, v32, 0
    s_nop 1
    v_mov_b32_dpp v16, v66 quad_perm:[0,0,0,0] row_mask:0xf bank_mask:0x3
    v_mov_b32_dpp v17, v66 quad_perm:[0,0,0,0] row_mask:0xf bank_mask:0xc
    v_mov_b32_dpp v18, v66 quad_perm:[1,1,1,1] row_mask:0xf bank_mask:0x3
    v_mov_b32_dpp v19, v66 quad_perm:[1,1,1,1] row_mask:0xf bank_mask:0xc
    v_mov_b32_dpp v20, v66 quad_perm:[2,2,2,2] row_mask:0xf bank_mask:0x3
    v_mov_b32_dpp v21, v66 quad_perm:[2,2,2,2] row_mask:0xf bank_mask:0xc
    v_mov_b32_dpp v22, v66 quad_perm:[3,3,3,3] row_mask:0xf bank_mask:0x3
    v_mov_b32_dpp v23, v66 quad_perm:[3,3,3,3] row_mask:0xf bank_mask:0xc
    v_smfmac_f32_16x16x64_bf16 v[24:27], v[16:19], v[96:103], v6
    v_smfmac_f32_16x16x64_bf16 v[28:31], v[16:19], v[104:111], v6
    v_smfmac_f32_16x16x64_bf16 v[24:27], v[20:23], v[112:119], v6
    v_smfmac_f32_16x16x64_bf16 v[28:31], v[20:23], v[120:127], v6
    s_nop 6
    ds_write_b128 v12, v[24:27] offset:10240
    ds_write_b128 v12, v[28:31] offset:20480
    s_waitcnt lgkmcnt(0)
    s_barrier
    ds_read2st64_b32 v[32:33], v68 offset0:40 offset1:45
    ds_read2st64_b32 v[34:35], v68 offset0:50 offset1:55
    ds_read2st64_b32 v[36:37], v68 offset0:60 offset1:65
    ds_read2st64_b32 v[38:39], v68 offset0:70 offset1:75
    s_waitcnt lgkmcnt(2)
    v_add_f32 v32, v32, v33
    v_add_f32 v34, v34, v35
    s_waitcnt lgkmcnt(0)
    v_add_f32 v36, v36, v37
    v_add_f32 v38, v38, v39
    v_add_f32 v32, v32, v34
    v_add_f32 v36, v36, v38
    v_add_f32 v32, v32, v36
    v_and_or_b32 v32, v32, s94, v10
    buffer_store_dword v32, v14, s[4:7], s92 offen sc1
L_pub_113:
    s_barrier
    s_cmp_ge_u32 s86, 2
    s_cbranch_scc1 L_A_norelay
    s_and_b32 s92, s86, 1
    s_lshl_b32 s92, s92, 3
    s_add_u32 s92, s92, s84
    s_and_b32 s90, s85, 3
    s_lshl_b32 s90, s90, 3
    s_lshr_b32 s91, s92, 1
    s_add_u32 s90, s90, s91
    s_lshl_b32 s90, s90, 13
    s_lshr_b32 s91, s85, 2
    s_lshl_b32 s91, s91, 9
    s_add_u32 s90, s90, s91
    s_and_b32 s91, s92, 1
    s_lshl_b32 s91, s91, 8
    s_add_u32 s90, s90, s91
    s_add_u32 s90, s90, 0x1000
    v_lshlrev_b32 v226, 10, v2
    v_lshl_add_u32 v226, v3, 4, v226
    v_add_u32 v226, s90, v226
    v_lshlrev_b32 v227, 4, v3
    v_lshl_add_u32 v227, v2, 2, v227
    s_lshl_b32 s92, s92, 8
    s_add_u32 s92, s92, s101
    s_add_u32 s92, s92, 0x14000
    s_mov_b32 s93, 0x1000
    buffer_load_dword v251, v227, s[4:7], s92 offen sc1
    s_sleep 8
    s_mov_b32 s96, 1
    s_branch L_poll_114
L_retry_116:
    s_sleep 4
    s_add_u32 s96, s96, 1
    s_cmp_ge_u32 s96, 48
    s_cbranch_scc1 L_rare_117
L_back_118:
    s_lshr_b64 s[80:81], vcc, 4
    s_or_b64 vcc, vcc, s[80:81]
    s_lshr_b64 s[80:81], vcc, 2
    s_or_b64 vcc, vcc, s[80:81]
    s_lshr_b64 s[80:81], vcc, 1
    s_or_b64 vcc, vcc, s[80:81]
    s_and_b32 s80, vcc_lo, 0x01010101
    s_and_b32 s81, vcc_hi, 0x01010101
    s_mul_i32 exec_lo, s80, 0xff
    s_mul_i32 exec_hi, s81, 0xff
L_poll_114:
    buffer_load_dwordx4 v[32:35], v226, s[4:7], 0 offen sc1
    buffer_load_dwordx4 v[36:39], v226, s[4:7], s93 offen sc1
    s_mov_b64 exec, -1
    s_waitcnt vmcnt(1)
    v_xor_b32 v15, v32, v10
    v_bitop3_b32 v15, v15, v35, v10 bitop3:0xf6
    s_waitcnt vmcnt(0)
    v_bitop3_b32 v15, v15, v36, v10 bitop3:0xf6
    v_bitop3_b32 v15, v15, v39, v10 bitop3:0xf6
    v_cmp_ne_u32_sdwa vcc, v15, v8 src0_sel:BYTE_0 src1_sel:DWORD
    s_cbranch_vccnz L_retry_116
L_ok_115:
    v_add_f32 v32, v32, v36
    v_add_f32 v33, v33, v37
    v_add_f32 v34, v34, v38
    v_add_f32 v35, v35, v39
    s_nop 0
    v_permlane32_swap_b32 v32, v34
    v_permlane32_swap_b32 v33, v35
    v_add_f32 v32, v32, v34
    v_add_f32 v33, v33, v35
    s_nop 1
    v_permlane16_swap_b32 v32, v33
    v_add_f32 v32, v32, v33
    v_and_or_b32 v32, v32, s94, v10
    buffer_store_dword v32, v227, s[4:7], s92 offen
    s_add_u32 s92, s92, 0x30000
    s_barrier
    buffer_store_dword v32, v227, s[4:7], s92 offen sc1
    buffer_load_dwordx4 v[80:83], v210, s[8:11], 0 offen nt
    s_mov_b32 s90, 0x6000
    buffer_load_dwordx4 v[84:87], v210, s[8:11], s90 offen nt
    buffer_load_dwordx4 v[128:131], v212, s[24:27], 0 offen nt
    s_mov_b32 s90, 0x1000
    buffer_load_dwordx4 v[132:135], v212, s[24:27], s90 offen nt
    s_branch L_A_p1issued
L_A_norelay:
    s_lshl_b32 s91, s86, 3
    s_add_u32 s91, s91, s84
    s_mul_i32 s91, s91, 640
    s_add_u32 s91, s91, s101
    s_add_u32 s91, s91, 0x12800
    s_add_u32 s80, s4, s91
    s_addc_u32 s81, s5, 0
    s_load_dword s100, s[80:81], 0
    s_load_dword s100, s[80:81], 64
    s_load_dword s100, s[80:81], 128
    s_load_dword s100, s[80:81], 192
    s_load_dword s100, s[80:81], 256
    s_load_dword s100, s[80:81], 320
    s_load_dword s100, s[80:81], 384
    s_load_dword s100, s[80:81], 448
    s_load_dword s100, s[80:81], 512
    s_load_dword s100, s[80:81], 576
    buffer_load_dwordx4 v[80:83], v210, s[8:11], 0 offen nt
    s_cmp_lt_u32 s86, 14
    s_cbranch_scc1 L_ex_119
    buffer_load_dwordx4 v[192:195], v210, s[8:11], 0 offen offset:2048 nt
    s_mov_b32 s90, 0x1000
    buffer_load_dwordx4 v[200:203], v210, s[8:11], s90 offen nt
L_ex_119:
    s_waitcnt vmcnt(0)
    s_waitcnt vmcnt(0)
    s_mov_b32 s90, 0x6000
    buffer_load_dwordx4 v[84:87], v210, s[8:11], s90 offen nt
    s_cmp_lt_u32 s86, 14
    s_cbranch_scc1 L_ex_120
    s_mov_b32 s90, 0x6000
    buffer_load_dwordx4 v[196:199], v210, s[8:11], s90 offen offset:2048 nt
    s_mov_b32 s90, 0x7000
    buffer_load_dwordx4 v[204:207], v210, s[8:11], s90 offen nt
L_ex_120:
    s_lshl_b32 s91, s86, 3
    s_add_u32 s91, s91, s84
    s_mul_i32 s91, s91, 448
    s_add_u32 s91, s91, s101
    s_add_u32 s91, s91, 0x2400
    s_add_u32 s80, s4, s91
    s_addc_u32 s81, s5, 0
    s_load_dword s100, s[80:81], 0
    s_load_dword s100, s[80:81], 64
    s_load_dword s100, s[80:81], 128
    s_load_dword s100, s[80:81], 192
    s_load_dword s100, s[80:81], 256
    s_load_dword s100, s[80:81], 320
    s_load_dword s100, s[80:81], 384
    s_lshl_b32 s91, s86, 3
    s_add_u32 s91, s91, s84
    s_mul_i32 s91, s91, 192
    s_add_u32 s91, s91, s101
    s_add_u32 s91, s91, 0x2a000
    s_add_u32 s80, s4, s91
    s_addc_u32 s81, s5, 0
    s_load_dword s100, s[80:81], 0
    s_load_dword s100, s[80:81], 64
    s_load_dword s100, s[80:81], 128
    s_waitcnt vmcnt(0)
    buffer_load_dwordx4 v[128:131], v212, s[24:27], 0 offen nt
    s_waitcnt vmcnt(0)
    s_mov_b32 s90, 0x1000
    buffer_load_dwordx4 v[132:135], v212, s[24:27], s90 offen nt
L_A_p1issued:
    v_lshlrev_b32 v40, 16, v216
    v_mul_f32 v41, 0xbfb8aa3b, v40
    v_exp_f32 v41, v41
    s_nop 0
    v_add_f32 v41, 1.0, v41
    v_rcp_f32 v42, v41
    s_nop 0
    v_mul_f32 v43, v40, v42
    v_cvt_pk_bf16_f32 v64, v43, 0
    s_cmp_lt_u32 s86, 8
    s_cbranch_scc1 L_A_norot
    v_mov_b32_dpp v64, v64 quad_perm:[2,3,2,3] row_mask:0xf bank_mask:0xf
L_A_norot:
    s_mul_i32 s92, s86, 224
    s_min_u32 s91, s84, 6
    s_lshl_b32 s91, s91, 5
    s_add_u32 s92, s92, s91
    s_lshl_b32 s91, s85, 8
    s_mul_i32 s92, s92, 2048
    s_add_u32 s92, s92, s91
    v_mul_u32_u24 v214, 2048, v7
    v_lshl_add_u32 v214, v3, 4, v214
    v_add_u32 v214, s92, v214
    s_lshl_b32 s92, s86, 3
    s_add_u32 s92, s92, s84
    s_lshl_b32 s92, s92, 7
    s_add_u32 s92, s92, 0x41000
    v_and_b32 v222, 3, v1
    v_lshl_add_u32 v222, v2, 2, v222
    v_lshlrev_b32 v222, 3, v222
    v_lshl_add_u32 v222, v4, 14, v222
    v_add_u32 v222, s92, v222
    v_lshrrev_b32 v32, 3, v1
    v_and_b32 v33, 7, v1
    s_mul_i32 s90, s86, 224
    s_min_u32 s91, s84, 6
    s_lshl_b32 s91, s91, 5
    s_add_u32 s90, s90, s91
    s_lshr_b32 s91, s90, 7
    s_and_b32 s90, s90, 127
    s_lshl_b32 s92, s91, 13
    s_lshl_b32 s90, s90, 3
    s_add_u32 s92, s92, s90
    s_add_u32 s92, s92, 0x380000
    v_lshlrev_b32 v224, 10, v32
    v_lshl_add_u32 v224, v33, 4, v224
    v_add_u32 v224, s92, v224
    s_lshl_b32 s92, s85, 10
    s_add_u32 s92, s92, 0x49000
    v_lshl_add_u32 v225, v32, 7, s92
    v_lshl_add_u32 v225, v4, 3, v225
    v_mov_b32 v24, 0
    v_mov_b32 v25, 0
    v_mov_b32 v26, 0
    v_mov_b32 v27, 0
    v_mov_b32 v28, 0
    v_mov_b32 v29, 0
    v_mov_b32 v30, 0
    v_mov_b32 v31, 0
    s_waitcnt vmcnt(3)
    s_mov_b32 s90, 0x4000
    buffer_load_dwordx4 v[136:139], v212, s[24:27], s90 offen nt
    s_waitcnt vmcnt(3)
    s_mov_b32 s90, 0x5000
    buffer_load_dwordx4 v[140:143], v212, s[24:27], s90 offen nt
    s_waitcnt vmcnt(3)
    s_mov_b32 s90, 0x8000
    buffer_load_dwordx4 v[144:147], v212, s[24:27], s90 offen nt
    v_mov_b32_dpp v16, v64 quad_perm:[0,0,0,0] row_mask:0xf bank_mask:0x3
    v_mov_b32_dpp v17, v64 quad_perm:[0,0,0,0] row_mask:0xf bank_mask:0xc
    v_mov_b32_dpp v18, v64 quad_perm:[1,1,1,1] row_mask:0xf bank_mask:0x3
    v_mov_b32_dpp v19, v64 quad_perm:[1,1,1,1] row_mask:0xf bank_mask:0xc
    s_nop 1
    v_smfmac_f32_16x16x64_bf16 v[72:75], v[16:19], v[80:87], v6
    s_lshl_b32 s92, s86, 10
    s_add_u32 s92, s92, s101
    s_add_u32 s92, s92, 0x4000
    s_nop 4
    ds_write_b128 v12, v[72:75] offset:51200
    s_cmp_lt_u32 s86, 14
    s_cbranch_scc1 L_A_nox1
    v_mov_b32 v88, 0
    v_mov_b32 v89, 0
    v_mov_b32 v90, 0
    v_mov_b32 v91, 0
    v_mov_b32 v92, 0
    v_mov_b32 v93, 0
    v_mov_b32 v94, 0
    v_mov_b32 v95, 0
    v_mov_b32_dpp v16, v64 quad_perm:[0,0,0,0] row_mask:0xf bank_mask:0x3
    v_mov_b32_dpp v17, v64 quad_perm:[0,0,0,0] row_mask:0xf bank_mask:0xc
    v_mov_b32_dpp v18, v64 quad_perm:[1,1,1,1] row_mask:0xf bank_mask:0x3
    v_mov_b32_dpp v19, v64 quad_perm:[1,1,1,1] row_mask:0xf bank_mask:0xc
    s_nop 1
    v_smfmac_f32_16x16x64_bf16 v[88:91], v[16:19], v[192:199], v6
    v_smfmac_f32_16x16x64_bf16 v[92:95], v[16:19], v[200:207], v6
    s_nop 6
    ds_write_b128 v12, v[88:91] offset:10240
    ds_write_b128 v12, v[92:95] offset:20480
L_A_nox1:
    s_waitcnt vmcnt(3)
    s_mov_b32 s90, 0x9000
    buffer_load_dwordx4 v[148:151], v212, s[24:27], s90 offen nt
    s_waitcnt vmcnt(3)
    s_mov_b32 s90, 0xc000
    buffer_load_dwordx4 v[152:155], v212, s[24:27], s90 offen nt
    s_waitcnt vmcnt(3)
    s_mov_b32 s90, 0xd000
    buffer_load_dwordx4 v[156:159], v212, s[24:27], s90 offen nt
    s_waitcnt lgkmcnt(0)
    s_barrier
    s_cmp_ge_u32 s84, 4
    s_cbranch_scc1 L_pub_121
    ds_read2st64_b32 v[32:33], v13 offset0:200 offset1:205
    ds_read2st64_b32 v[34:35], v13 offset0:210 offset1:215
    ds_read2st64_b32 v[36:37], v13 offset0:220 offset1:225
    ds_read2st64_b32 v[38:39], v13 offset0:230 offset1:235
    s_waitcnt lgkmcnt(2)
    v_add_f32 v32, v32, v33
    v_add_f32 v34, v34, v35
    s_waitcnt lgkmcnt(0)
    v_add_f32 v36, v36, v37
    v_add_f32 v38, v38, v39
    v_add_f32 v32, v32, v34
    v_add_f32 v36, v36, v38
    v_add_f32 v32, v32, v36
    v_and_or_b32 v32, v32, s94, v10
    buffer_store_dword v32, v14, s[4:7], s92 offen
L_pub_121:
    s_barrier
    s_cmp_lt_u32 s86, 14
    s_cbranch_scc1 L_A_nox2
    s_cmp_lt_u32 s84, 4
    s_cselect_b32 s92, 0x24000, 0
    s_add_u32 s92, s92, s101
    s_lshl_b32 s91, s86, 10
    s_add_u32 s92, s92, s91
    s_add_u32 s92, s92, 0x8000
    ds_read2st64_b32 v[32:33], v13 offset0:40 offset1:45
    ds_read2st64_b32 v[34:35], v13 offset0:50 offset1:55
    ds_read2st64_b32 v[36:37], v13 offset0:60 offset1:65
    ds_read2st64_b32 v[38:39], v13 offset0:70 offset1:75
    s_waitcnt lgkmcnt(2)
    v_add_f32 v32, v32, v33
    v_add_f32 v34, v34, v35
    s_waitcnt lgkmcnt(0)
    v_add_f32 v36, v36, v37
    v_add_f32 v38, v38, v39
    v_add_f32 v32, v32, v34
    v_add_f32 v36, v36, v38
    v_add_f32 v32, v32, v36
    v_and_or_b32 v32, v32, s94, v10
    buffer_store_dword v32, v14, s[4:7], s92 offen
L_pub_122:
    s_barrier
L_A_nox2:
    s_lshl_b32 s92, s86, 10
    s_add_u32 s92, s92, s101
    s_add_u32 s92, s92, 0xc000
    s_mov_b32 s89, 0
    buffer_load_dwordx2 v[66:67], v222, s[4:7], 0 offen sc1
    s_add_u32 s76, s101, 0x15000
    v_lshlrev_b32 v69, 2, v3
    s_waitcnt vmcnt(0)
    v_xor_b32 v15, v66, v10
    v_bitop3_b32 v15, v15, v67, v10 bitop3:0xf6
    v_cmp_ne_u32_sdwa vcc, v15, v8 src0_sel:BYTE_0 src1_sel:DWORD
    s_cbranch_vccz L_A_ook
    s_mov_b32 s96, 0
L_sp_123:
    buffer_load_dword v15, v69, s[4:7], s76 offen sc1
    s_add_u32 s96, s96, 1
    s_waitcnt vmcnt(0)
    v_cmp_ne_u32 vcc, v15, v70
    s_cbranch_vccz L_spok_124
    s_sleep 2
    s_cmp_lt_u32 s96, 200
    s_cbranch_scc1 L_sp_123
L_spok_124:
    s_cmp_eq_u32 s96, 1
    s_cbranch_scc1 L_A_nod3
    s_sleep 8
L_A_nod3:
    s_mov_b32 s96, 1
    s_branch L_poll_125
L_retry_127:
    s_sleep 2
    s_add_u32 s96, s96, 1
    s_cmp_ge_u32 s96, 48
    s_cbranch_scc1 L_rare_128
L_back_129:
    s_lshr_b64 s[80:81], vcc, 4
    s_or_b64 vcc, vcc, s[80:81]
    s_lshr_b64 s[80:81], vcc, 2
    s_or_b64 vcc, vcc, s[80:81]
    s_lshr_b64 s[80:81], vcc, 1
    s_or_b64 vcc, vcc, s[80:81]
    s_and_b32 s80, vcc_lo, 0x01010101
    s_and_b32 s81, vcc_hi, 0x01010101
    s_mul_i32 exec_lo, s80, 0xff
    s_mul_i32 exec_hi, s81, 0xff
L_poll_125:
    buffer_load_dwordx2 v[66:67], v222, s[4:7], 0 offen sc1
    s_mov_b64 exec, -1
    s_waitcnt vmcnt(0)
    v_xor_b32 v15, v66, v10
    v_bitop3_b32 v15, v15, v67, v10 bitop3:0xf6
    v_cmp_ne_u32_sdwa vcc, v15, v8 src0_sel:BYTE_0 src1_sel:DWORD
    s_cbranch_vccnz L_retry_127
L_ok_126:
L_A_ook:
    v_mov_b32_dpp v16, v66 quad_perm:[0,0,0,0] row_mask:0xf bank_mask:0x3
    v_mov_b32_dpp v17, v66 quad_perm:[0,0,0,0] row_mask:0xf bank_mask:0xc
    v_mov_b32_dpp v18, v66 quad_perm:[1,1,1,1] row_mask:0xf bank_mask:0x3
    v_mov_b32_dpp v19, v66 quad_perm:[1,1,1,1] row_mask:0xf bank_mask:0xc
    v_mov_b32_dpp v20, v66 quad_perm:[2,2,2,2] row_mask:0xf bank_mask:0x3
    v_mov_b32_dpp v21, v66 quad_perm:[2,2,2,2] row_mask:0xf bank_mask:0xc
    v_mov_b32_dpp v22, v66 quad_perm:[3,3,3,3] row_mask:0xf bank_mask:0x3
    v_mov_b32_dpp v23, v66 quad_perm:[3,3,3,3] row_mask:0xf bank_mask:0xc
    v_smfmac_f32_16x16x64_bf16 v[24:27], v[16:19], v[128:135], v6
    v_mov_b32_dpp v16, v67 quad_perm:[0,0,0,0] row_mask:0xf bank_mask:0x3
    v_mov_b32_dpp v17, v67 quad_perm:[0,0,0,0] row_mask:0xf bank_mask:0xc
    v_mov_b32_dpp v18, v67 quad_perm:[1,1,1,1] row_mask:0xf bank_mask:0x3
    v_mov_b32_dpp v19, v67 quad_perm:[1,1,1,1] row_mask:0xf bank_mask:0xc
    v_smfmac_f32_16x16x64_bf16 v[24:27], v[20:23], v[136:143], v6
    v_mov_b32_dpp v20, v67 quad_perm:[2,2,2,2] row_mask:0xf bank_mask:0x3
    v_mov_b32_dpp v21, v67 quad_perm:[2,2,2,2] row_mask:0xf bank_mask:0xc
    v_mov_b32_dpp v22, v67 quad_perm:[3,3,3,3] row_mask:0xf bank_mask:0x3
    v_mov_b32_dpp v23, v67 quad_perm:[3,3,3,3] row_mask:0xf bank_mask:0xc
    v_smfmac_f32_16x16x64_bf16 v[24:27], v[16:19], v[144:151], v6
    s_nop 0
    v_smfmac_f32_16x16x64_bf16 v[24:27], v[20:23], v[152:159], v6
    s_nop 7
    ds_write_b128 v12, v[24:27] offset:30720
    s_waitcnt lgkmcnt(0)
    s_barrier
    s_cmp_ge_u32 s84, 4
    s_cbranch_scc1 L_pub_134
    ds_read2st64_b32 v[32:33], v13 offset0:120 offset1:125
    ds_read2st64_b32 v[34:35], v13 offset0:130 offset1:135
    ds_read2st64_b32 v[36:37], v13 offset0:140 offset1:145
    ds_read2st64_b32 v[38:39], v13 offset0:150 offset1:155
    s_waitcnt lgkmcnt(2)
    v_add_f32 v32, v32, v33
    v_add_f32 v34, v34, v35
    s_waitcnt lgkmcnt(0)
    v_add_f32 v36, v36, v37
    v_add_f32 v38, v38, v39
    v_add_f32 v32, v32, v34
    v_add_f32 v36, v36, v38
    v_add_f32 v32, v32, v36
    v_and_or_b32 v32, v32, s94, v10
    buffer_store_dword v32, v14, s[4:7], s92 offen
L_pub_134:
    s_barrier
    s_lshl_b32 s92, s86, 10
    s_add_u32 s92, s92, s101
    s_add_u32 s92, s92, 0x10000
    s_cmp_eq_u32 s84, 7
    s_cbranch_scc1 L_A_w2skip
    buffer_load_dwordx4 v[160:163], v214, s[32:35], 0 offen nt
    s_mov_b32 s90, 0x1000
    buffer_load_dwordx4 v[164:167], v214, s[32:35], s90 offen nt
    s_mov_b32 s90, 0x4000
    buffer_load_dwordx4 v[168:171], v214, s[32:35], s90 offen nt
    s_mov_b32 s90, 0x5000
    buffer_load_dwordx4 v[172:175], v214, s[32:35], s90 offen nt
    s_mov_b32 s90, 0x8000
    buffer_load_dwordx4 v[176:179], v214, s[32:35], s90 offen nt
    s_waitcnt vmcnt(4)
    s_mov_b32 s90, 0x9000
    buffer_load_dwordx4 v[180:183], v214, s[32:35], s90 offen nt
    s_waitcnt vmcnt(4)
    s_mov_b32 s90, 0xc000
    buffer_load_dwordx4 v[184:187], v214, s[32:35], s90 offen nt
    s_waitcnt vmcnt(4)
    s_mov_b32 s90, 0xd000
    buffer_load_dwordx4 v[188:191], v214, s[32:35], s90 offen nt
L_A_w2skip:
    s_cmp_lg_u32 s84, 7
    s_cbranch_scc1 L_hok_136
    s_add_u32 s76, s101, 0x15080
    s_mov_b32 s96, 0
    v_min_u32 v69, 13, v1
    v_lshlrev_b32 v69, 2, v69
L_hint_135:
    buffer_load_dword v15, v69, s[4:7], s76 offen sc1
    s_add_u32 s96, s96, 1
    s_waitcnt vmcnt(0)
    v_cmp_ne_u32 vcc, v15, v70
    s_cbranch_vccz L_hseen_137
    s_sleep 1
    s_cmp_lt_u32 s96, 200
    s_cbranch_scc1 L_hint_135
L_hseen_137:
    s_cmp_eq_u32 s96, 1
    s_cbranch_scc1 L_hok_136
    s_sleep 14
L_hok_136:
    s_barrier
    s_cmp_eq_u32 s84, 7
    s_cbranch_scc1 L_A_p6skip
    s_mov_b32 s96, 1
    s_branch L_poll_138
L_retry_140:
    s_sleep 4
    s_add_u32 s96, s96, 1
    s_cmp_ge_u32 s96, 48
    s_cbranch_scc1 L_rare_141
L_back_142:
    s_lshr_b64 s[80:81], vcc, 4
    s_or_b64 vcc, vcc, s[80:81]
    s_lshr_b64 s[80:81], vcc, 2
    s_or_b64 vcc, vcc, s[80:81]
    s_lshr_b64 s[80:81], vcc, 1
    s_or_b64 vcc, vcc, s[80:81]
    s_and_b32 s80, vcc_lo, 0x01010101
    s_and_b32 s81, vcc_hi, 0x01010101
    s_mul_i32 exec_lo, s80, 0xff
    s_mul_i32 exec_hi, s81, 0xff
L_poll_138:
    buffer_load_dwordx4 v[32:35], v224, s[4:7], 0 offen sc1
    buffer_load_dwordx4 v[36:39], v224, s[4:7], 0 offen offset:128 sc1
    s_mov_b64 exec, -1
    s_waitcnt vmcnt(1)
    v_xor_b32 v15, v32, v10
    v_bitop3_b32 v15, v15, v35, v10 bitop3:0xf6
    s_waitcnt vmcnt(0)
    v_bitop3_b32 v15, v15, v36, v10 bitop3:0xf6
    v_bitop3_b32 v15, v15, v39, v10 bitop3:0xf6
    v_cmp_ne_u32_sdwa vcc, v15, v8 src0_sel:BYTE_0 src1_sel:DWORD
    s_cbranch_vccnz L_retry_140
L_ok_139:
    v_permlane32_swap_b32 v32, v34
    v_permlane32_swap_b32 v33, v35
    v_permlane32_swap_b32 v36, v38
    v_permlane32_swap_b32 v37, v39
    v_add_f32 v32, v32, v34
    v_add_f32 v33, v33, v35
    v_add_f32 v36, v36, v38
    v_add_f32 v37, v37, v39
    v_permlane16_swap_b32 v32, v33
    s_nop 0
    v_permlane16_swap_b32 v36, v37
    v_add_f32 v32, v32, v33
    v_add_f32 v36, v36, v37
    s_nop 0
    v_add_f32_dpp v32, v32, v32 row_ror:8 row_mask:0xf bank_mask:0xf
    v_add_f32_dpp v36, v36, v36 row_ror:8 row_mask:0xf bank_mask:0xf
    v_max_f32 v32, 0, v32
    v_max_f32 v36, 0, v36
    v_cvt_pk_bf16_f32 v66, v32, 0
    v_cvt_pk_bf16_f32 v67, v36, 0
    s_nop 0
    v_mov_b32_dpp v16, v66 quad_perm:[0,0,0,0] row_mask:0xf bank_mask:0x3
    v_mov_b32_dpp v17, v66 quad_perm:[0,0,0,0] row_mask:0xf bank_mask:0xc
    v_mov_b32_dpp v18, v66 quad_perm:[1,1,1,1] row_mask:0xf bank_mask:0x3
    v_mov_b32_dpp v19, v66 quad_perm:[1,1,1,1] row_mask:0xf bank_mask:0xc
    v_mov_b32_dpp v20, v66 quad_perm:[2,2,2,2] row_mask:0xf bank_mask:0x3
    v_mov_b32_dpp v21, v66 quad_perm:[2,2,2,2] row_mask:0xf bank_mask:0xc
    v_mov_b32_dpp v22, v66 quad_perm:[3,3,3,3] row_mask:0xf bank_mask:0x3
    v_mov_b32_dpp v23, v66 quad_perm:[3,3,3,3] row_mask:0xf bank_mask:0xc
    v_smfmac_f32_16x16x64_bf16 v[28:31], v[16:19], v[160:167], v6
    v_mov_b32_dpp v16, v67 quad_perm:[0,0,0,0] row_mask:0xf bank_mask:0x3
    v_mov_b32_dpp v17, v67 quad_perm:[0,0,0,0] row_mask:0xf bank_mask:0xc
    v_mov_b32_dpp v18, v67 quad_perm:[1,1,1,1] row_mask:0xf bank_mask:0x3
    v_mov_b32_dpp v19, v67 quad_perm:[1,1,1,1] row_mask:0xf bank_mask:0xc
    v_smfmac_f32_16x16x64_bf16 v[28:31], v[20:23], v[168:175], v6
    v_mov_b32_dpp v20, v67 quad_perm:[2,2,2,2] row_mask:0xf bank_mask:0x3
    v_mov_b32_dpp v21, v67 quad_perm:[2,2,2,2] row_mask:0xf bank_mask:0xc
    v_mov_b32_dpp v22, v67 quad_perm:[3,3,3,3] row_mask:0xf bank_mask:0x3
    v_mov_b32_dpp v23, v67 quad_perm:[3,3,3,3] row_mask:0xf bank_mask:0xc
    v_smfmac_f32_16x16x64_bf16 v[28:31], v[16:19], v[176:183], v6
    s_nop 0
    v_smfmac_f32_16x16x64_bf16 v[28:31], v[20:23], v[184:191], v6
L_A_p6skip:
    s_nop 7
    ds_write_b128 v12, v[28:31] offset:40960
    s_waitcnt lgkmcnt(0)
    s_barrier
    s_cmp_ge_u32 s84, 4
    s_cbranch_scc1 L_pub_148
    ds_read2st64_b32 v[32:33], v13 offset0:160 offset1:165
    ds_read2st64_b32 v[34:35], v13 offset0:170 offset1:175
    ds_read2st64_b32 v[36:37], v13 offset0:180 offset1:185
    ds_read2st64_b32 v[38:39], v13 offset0:190 offset1:195
    s_waitcnt lgkmcnt(2)
    v_add_f32 v32, v32, v33
    v_add_f32 v34, v34, v35
    s_waitcnt lgkmcnt(0)
    v_add_f32 v36, v36, v37
    v_add_f32 v38, v38, v39
    v_add_f32 v32, v32, v34
    v_add_f32 v36, v36, v38
    v_add_f32 v32, v32, v36
    v_and_or_b32 v32, v32, s94, v10
    buffer_store_dword v32, v14, s[4:7], s92 offen
L_pub_148:
    s_barrier
    s_cmp_ge_u32 s84, 4
    s_cbranch_scc1 L_pb2_149
    s_add_u32 s92, s92, 0x30000
    buffer_store_dword v32, v14, s[4:7], s92 offen sc1
L_pb2_149:
    s_endpgm
L_rare_5:
    s_cmp_ge_u32 s96, 40000
    s_cbranch_scc1 L_ok_3
    s_and_b32 s90, s96, 63
    s_cmp_lg_u32 s90, 52
    s_cbranch_scc1 L_of_7
    s_lshl_b32 s90, s86, 10
    s_add_u32 s90, s90, s101
    s_add_u32 s90, s90, 0x0
    v_lshlrev_b32 v15, 4, v1
    buffer_load_dwordx4 v[228:231], v15, s[4:7], s90 offen offset:0 sc1
    s_add_u32 s90, s90, 0x30000
    s_waitcnt vmcnt(0)
    buffer_store_dwordx4 v[228:231], v15, s[4:7], s90 offen offset:0 sc1
    s_sub_u32 s90, s90, 0x30000
    s_waitcnt vmcnt(0)
L_of_7:
    s_and_b32 s90, s96, 15
    s_cmp_eq_u32 s90, 15
    s_cselect_b32 s90, 0x30000, 0
    s_add_u32 s90, s90, s101
    s_add_u32 s76, s90, 0x14000
    s_branch L_back_6
L_rare_14:
    s_cmp_ge_u32 s96, 40000
    s_cbranch_scc1 L_ok_12
    s_and_b32 s90, s96, 63
    s_cmp_lg_u32 s90, 52
    s_cbranch_scc1 L_of_16
    s_lshl_b32 s90, s86, 10
    s_add_u32 s90, s90, s101
    s_add_u32 s90, s90, 0x0
    v_lshlrev_b32 v15, 4, v1
    buffer_load_dwordx4 v[228:231], v15, s[4:7], s90 offen offset:0 sc1
    s_add_u32 s90, s90, 0x30000
    s_waitcnt vmcnt(0)
    buffer_store_dwordx4 v[228:231], v15, s[4:7], s90 offen offset:0 sc1
    s_sub_u32 s90, s90, 0x30000
    s_waitcnt vmcnt(0)
    s_lshl_b32 s90, s86, 12
    s_add_u32 s90, s90, s101
    s_add_u32 s90, s90, 0x16000
    v_lshlrev_b32 v15, 4, v1
    buffer_load_dwordx4 v[228:231], v15, s[4:7], s90 offen offset:0 sc1
    s_add_u32 s90, s90, 0x30000
    s_waitcnt vmcnt(0)
    buffer_store_dwordx4 v[228:231], v15, s[4:7], s90 offen offset:0 sc1
    s_sub_u32 s90, s90, 0x30000
    s_waitcnt vmcnt(0)
    buffer_load_dwordx4 v[228:231], v15, s[4:7], s90 offen offset:1024 sc1
    s_add_u32 s90, s90, 0x30000
    s_waitcnt vmcnt(0)
    buffer_store_dwordx4 v[228:231], v15, s[4:7], s90 offen offset:1024 sc1
    s_sub_u32 s90, s90, 0x30000
    s_waitcnt vmcnt(0)
    buffer_load_dwordx4 v[228:231], v15, s[4:7], s90 offen offset:2048 sc1
    s_add_u32 s90, s90, 0x30000
    s_waitcnt vmcnt(0)
    buffer_store_dwordx4 v[228:231], v15, s[4:7], s90 offen offset:2048 sc1
    s_sub_u32 s90, s90, 0x30000
    s_waitcnt vmcnt(0)
    buffer_load_dwordx4 v[228:231], v15, s[4:7], s90 offen offset:3072 sc1
    s_add_u32 s90, s90, 0x30000
    s_waitcnt vmcnt(0)
    buffer_store_dwordx4 v[228:231], v15, s[4:7], s90 offen offset:3072 sc1
    s_sub_u32 s90, s90, 0x30000
    s_waitcnt vmcnt(0)
    s_lshl_b32 s90, s86, 7
    s_add_u32 s90, s90, s101
    s_add_u32 s90, s90, 0x26000
    v_lshlrev_b32 v15, 4, v1
    v_and_b32 v15, 127, v15
    buffer_load_dwordx4 v[228:231], v15, s[4:7], s90 offen offset:0 sc1
    s_add_u32 s90, s90, 0x30000
    s_waitcnt vmcnt(0)
    buffer_store_dwordx4 v[228:231], v15, s[4:7], s90 offen offset:0 sc1
    s_sub_u32 s90, s90, 0x30000
    s_waitcnt vmcnt(0)
    s_lshl_b32 s90, s86, 10
    s_add_u32 s90, s90, s101
    s_add_u32 s90, s90, 0x8000
    v_lshlrev_b32 v15, 4, v1
    buffer_load_dwordx4 v[228:231], v15, s[4:7], s90 offen offset:0 sc1
    s_add_u32 s90, s90, 0x30000
    s_waitcnt vmcnt(0)
    buffer_store_dwordx4 v[228:231], v15, s[4:7], s90 offen offset:0 sc1
    s_sub_u32 s90, s90, 0x30000
    s_waitcnt vmcnt(0)
    s_lshl_b32 s90, s86, 10
    s_add_u32 s90, s90, s101
    s_add_u32 s90, s90, 0x2c000
    v_lshlrev_b32 v15, 4, v1
    buffer_load_dwordx4 v[228:231], v15, s[4:7], s90 offen offset:0 sc1
    s_add_u32 s90, s90, 0x30000
    s_waitcnt vmcnt(0)
    buffer_store_dwordx4 v[228:231], v15, s[4:7], s90 offen offset:0 sc1
    s_sub_u32 s90, s90, 0x30000
    s_waitcnt vmcnt(0)
L_of_16:
    s_and_b32 s90, s96, 15
    s_cmp_eq_u32 s90, 15
    s_cselect_b32 s90, 0x30000, 0
    s_add_u32 s90, s90, s101
    s_add_u32 s76, s90, 0x26800
    s_branch L_back_15
L_rare_25:
    s_cmp_ge_u32 s96, 40000
    s_cbranch_scc1 L_ok_23
    s_and_b32 s90, s96, 63
    s_cmp_lg_u32 s90, 52
    s_cbranch_scc1 L_of_27
    s_lshl_b32 s90, s86, 10
    s_add_u32 s90, s90, s101
    s_add_u32 s90, s90, 0x0
    v_lshlrev_b32 v15, 4, v1
    buffer_load_dwordx4 v[228:231], v15, s[4:7], s90 offen offset:0 sc1
    s_add_u32 s90, s90, 0x30000
    s_waitcnt vmcnt(0)
    buffer_store_dwordx4 v[228:231], v15, s[4:7], s90 offen offset:0 sc1
    s_sub_u32 s90, s90, 0x30000
    s_waitcnt vmcnt(0)
    s_lshl_b32 s90, s86, 12
    s_add_u32 s90, s90, s101
    s_add_u32 s90, s90, 0x16000
    v_lshlrev_b32 v15, 4, v1
    buffer_load_dwordx4 v[228:231], v15, s[4:7], s90 offen offset:0 sc1
    s_add_u32 s90, s90, 0x30000
    s_waitcnt vmcnt(0)
    buffer_store_dwordx4 v[228:231], v15, s[4:7], s90 offen offset:0 sc1
    s_sub_u32 s90, s90, 0x30000
    s_waitcnt vmcnt(0)
    buffer_load_dwordx4 v[228:231], v15, s[4:7], s90 offen offset:1024 sc1
    s_add_u32 s90, s90, 0x30000
    s_waitcnt vmcnt(0)
    buffer_store_dwordx4 v[228:231], v15, s[4:7], s90 offen offset:1024 sc1
    s_sub_u32 s90, s90, 0x30000
    s_waitcnt vmcnt(0)
    buffer_load_dwordx4 v[228:231], v15, s[4:7], s90 offen offset:2048 sc1
    s_add_u32 s90, s90, 0x30000
    s_waitcnt vmcnt(0)
    buffer_store_dwordx4 v[228:231], v15, s[4:7], s90 offen offset:2048 sc1
    s_sub_u32 s90, s90, 0x30000
    s_waitcnt vmcnt(0)
    buffer_load_dwordx4 v[228:231], v15, s[4:7], s90 offen offset:3072 sc1
    s_add_u32 s90, s90, 0x30000
    s_waitcnt vmcnt(0)
    buffer_store_dwordx4 v[228:231], v15, s[4:7], s90 offen offset:3072 sc1
    s_sub_u32 s90, s90, 0x30000
    s_waitcnt vmcnt(0)
    s_lshl_b32 s90, s86, 7
    s_add_u32 s90, s90, s101
    s_add_u32 s90, s90, 0x26000
    v_lshlrev_b32 v15, 4, v1
    v_and_b32 v15, 127, v15
    buffer_load_dwordx4 v[228:231], v15, s[4:7], s90 offen offset:0 sc1
    s_add_u32 s90, s90, 0x30000
    s_waitcnt vmcnt(0)
    buffer_store_dwordx4 v[228:231], v15, s[4:7], s90 offen offset:0 sc1
    s_sub_u32 s90, s90, 0x30000
    s_waitcnt vmcnt(0)
    s_lshl_b32 s90, s86, 10
    s_add_u32 s90, s90, s101
    s_add_u32 s90, s90, 0x8000
    v_lshlrev_b32 v15, 4, v1
    buffer_load_dwordx4 v[228:231], v15, s[4:7], s90 offen offset:0 sc1
    s_add_u32 s90, s90, 0x30000
    s_waitcnt vmcnt(0)
    buffer_store_dwordx4 v[228:231], v15, s[4:7], s90 offen offset:0 sc1
    s_sub_u32 s90, s90, 0x30000
    s_waitcnt vmcnt(0)
    s_lshl_b32 s90, s86, 10
    s_add_u32 s90, s90, s101
    s_add_u32 s90, s90, 0x2c000
    v_lshlrev_b32 v15, 4, v1
    buffer_load_dwordx4 v[228:231], v15, s[4:7], s90 offen offset:0 sc1
    s_add_u32 s90, s90, 0x30000
    s_waitcnt vmcnt(0)
    buffer_store_dwordx4 v[228:231], v15, s[4:7], s90 offen offset:0 sc1
    s_sub_u32 s90, s90, 0x30000
    s_waitcnt vmcnt(0)
L_of_27:
    s_branch L_back_26
L_rare_39:
    s_cmp_ge_u32 s96, 40000
    s_cbranch_scc1 L_ok_37
    s_and_b32 s90, s96, 63
    s_cmp_lg_u32 s90, 52
    s_cbranch_scc1 L_of_41
    s_lshl_b32 s90, s86, 10
    s_add_u32 s90, s90, s101
    s_add_u32 s90, s90, 0x0
    v_lshlrev_b32 v15, 4, v1
    buffer_load_dwordx4 v[228:231], v15, s[4:7], s90 offen offset:0 sc1
    s_add_u32 s90, s90, 0x30000
    s_waitcnt vmcnt(0)
    buffer_store_dwordx4 v[228:231], v15, s[4:7], s90 offen offset:0 sc1
    s_sub_u32 s90, s90, 0x30000
    s_waitcnt vmcnt(0)
    s_lshl_b32 s90, s86, 12
    s_add_u32 s90, s90, s101
    s_add_u32 s90, s90, 0x16000
    v_lshlrev_b32 v15, 4, v1
    buffer_load_dwordx4 v[228:231], v15, s[4:7], s90 offen offset:0 sc1
    s_add_u32 s90, s90, 0x30000
    s_waitcnt vmcnt(0)
    buffer_store_dwordx4 v[228:231], v15, s[4:7], s90 offen offset:0 sc1
    s_sub_u32 s90, s90, 0x30000
    s_waitcnt vmcnt(0)
    buffer_load_dwordx4 v[228:231], v15, s[4:7], s90 offen offset:1024 sc1
    s_add_u32 s90, s90, 0x30000
    s_waitcnt vmcnt(0)
    buffer_store_dwordx4 v[228:231], v15, s[4:7], s90 offen offset:1024 sc1
    s_sub_u32 s90, s90, 0x30000
    s_waitcnt vmcnt(0)
    buffer_load_dwordx4 v[228:231], v15, s[4:7], s90 offen offset:2048 sc1
    s_add_u32 s90, s90, 0x30000
    s_waitcnt vmcnt(0)
    buffer_store_dwordx4 v[228:231], v15, s[4:7], s90 offen offset:2048 sc1
    s_sub_u32 s90, s90, 0x30000
    s_waitcnt vmcnt(0)
    buffer_load_dwordx4 v[228:231], v15, s[4:7], s90 offen offset:3072 sc1
    s_add_u32 s90, s90, 0x30000
    s_waitcnt vmcnt(0)
    buffer_store_dwordx4 v[228:231], v15, s[4:7], s90 offen offset:3072 sc1
    s_sub_u32 s90, s90, 0x30000
    s_waitcnt vmcnt(0)
    s_lshl_b32 s90, s86, 7
    s_add_u32 s90, s90, s101
    s_add_u32 s90, s90, 0x26000
    v_lshlrev_b32 v15, 4, v1
    v_and_b32 v15, 127, v15
    buffer_load_dwordx4 v[228:231], v15, s[4:7], s90 offen offset:0 sc1
    s_add_u32 s90, s90, 0x30000
    s_waitcnt vmcnt(0)
    buffer_store_dwordx4 v[228:231], v15, s[4:7], s90 offen offset:0 sc1
    s_sub_u32 s90, s90, 0x30000
    s_waitcnt vmcnt(0)
L_of_41:
    s_cmp_lg_u32 s96, 48
    s_cbranch_scc1 L_inv_45
    v_not_b32 v228, v70
    v_not_b32 v229, v70
    v_not_b32 v230, v70
    v_not_b32 v231, v70
    s_add_u32 s90, s101, 0x56000
    buffer_store_dwordx4 v[228:231], v253, s[4:7], s90 offen offset:0 sc1
    s_add_u32 s90, s101, 0x56000
    buffer_store_dwordx4 v[228:231], v253, s[4:7], s90 offen offset:1024 sc1
    s_waitcnt vmcnt(0)
L_inv_45:
    s_and_b32 s90, s96, 15
    s_cmp_eq_u32 s90, 15
    s_cselect_b32 s90, 0x30000, 0
    s_add_u32 s90, s90, s101
    s_add_u32 s76, s90, 0x26000
    s_branch L_back_40
L_rare_49:
    s_cmp_ge_u32 s96, 40000
    s_cbranch_scc1 L_ok_47
    s_and_b32 s90, s96, 63
    s_cmp_lg_u32 s90, 52
    s_cbranch_scc1 L_of_51
    s_lshl_b32 s90, s86, 10
    s_add_u32 s90, s90, s101
    s_add_u32 s90, s90, 0x0
    v_lshlrev_b32 v15, 4, v1
    buffer_load_dwordx4 v[228:231], v15, s[4:7], s90 offen offset:0 sc1
    s_add_u32 s90, s90, 0x30000
    s_waitcnt vmcnt(0)
    buffer_store_dwordx4 v[228:231], v15, s[4:7], s90 offen offset:0 sc1
    s_sub_u32 s90, s90, 0x30000
    s_waitcnt vmcnt(0)
    s_lshl_b32 s90, s86, 12
    s_add_u32 s90, s90, s101
    s_add_u32 s90, s90, 0x16000
    v_lshlrev_b32 v15, 4, v1
    buffer_load_dwordx4 v[228:231], v15, s[4:7], s90 offen offset:0 sc1
    s_add_u32 s90, s90, 0x30000
    s_waitcnt vmcnt(0)
    buffer_store_dwordx4 v[228:231], v15, s[4:7], s90 offen offset:0 sc1
    s_sub_u32 s90, s90, 0x30000
    s_waitcnt vmcnt(0)
    buffer_load_dwordx4 v[228:231], v15, s[4:7], s90 offen offset:1024 sc1
    s_add_u32 s90, s90, 0x30000
    s_waitcnt vmcnt(0)
    buffer_store_dwordx4 v[228:231], v15, s[4:7], s90 offen offset:1024 sc1
    s_sub_u32 s90, s90, 0x30000
    s_waitcnt vmcnt(0)
    buffer_load_dwordx4 v[228:231], v15, s[4:7], s90 offen offset:2048 sc1
    s_add_u32 s90, s90, 0x30000
    s_waitcnt vmcnt(0)
    buffer_store_dwordx4 v[228:231], v15, s[4:7], s90 offen offset:2048 sc1
    s_sub_u32 s90, s90, 0x30000
    s_waitcnt vmcnt(0)
    buffer_load_dwordx4 v[228:231], v15, s[4:7], s90 offen offset:3072 sc1
    s_add_u32 s90, s90, 0x30000
    s_waitcnt vmcnt(0)
    buffer_store_dwordx4 v[228:231], v15, s[4:7], s90 offen offset:3072 sc1
    s_sub_u32 s90, s90, 0x30000
    s_waitcnt vmcnt(0)
    s_lshl_b32 s90, s86, 7
    s_add_u32 s90, s90, s101
    s_add_u32 s90, s90, 0x26000
    v_lshlrev_b32 v15, 4, v1
    v_and_b32 v15, 127, v15
    buffer_load_dwordx4 v[228:231], v15, s[4:7], s90 offen offset:0 sc1
    s_add_u32 s90, s90, 0x30000
    s_waitcnt vmcnt(0)
    buffer_store_dwordx4 v[228:231], v15, s[4:7], s90 offen offset:0 sc1
    s_sub_u32 s90, s90, 0x30000
    s_waitcnt vmcnt(0)
L_of_51:
    s_cmp_lg_u32 s96, 48
    s_cbranch_scc1 L_inv_55
    v_not_b32 v228, v70
    v_not_b32 v229, v70
    v_not_b32 v230, v70
    v_not_b32 v231, v70
    s_add_u32 s90, s101, 0x46000
    buffer_store_dwordx4 v[228:231], v252, s[4:7], s90 offen offset:0 sc1
    s_add_u32 s90, s101, 0x46000
    buffer_store_dwordx4 v[228:231], v252, s[4:7], s90 offen offset:128 sc1
    s_add_u32 s90, s101, 0x4e000
    buffer_store_dwordx4 v[228:231], v252, s[4:7], s90 offen offset:0 sc1
    s_add_u32 s90, s101, 0x4e000
    buffer_store_dwordx4 v[228:231], v252, s[4:7], s90 offen offset:128 sc1
    s_waitcnt vmcnt(0)
L_inv_55:
    s_and_b32 s90, s96, 15
    s_cmp_eq_u32 s90, 15
    s_cselect_b32 s90, 0x30000, 0
    s_add_u32 s90, s90, s101
    s_add_u32 s76, s90, 0x16000
    s_add_u32 s77, s90, 0x1e000
    s_branch L_back_50
L_rare_59:
    s_cmp_ge_u32 s96, 40000
    s_cbranch_scc1 L_ok_57
    s_and_b32 s90, s96, 63
    s_cmp_lg_u32 s90, 52
    s_cbranch_scc1 L_of_61
    s_lshl_b32 s90, s86, 10
    s_add_u32 s90, s90, s101
    s_add_u32 s90, s90, 0x0
    v_lshlrev_b32 v15, 4, v1
    buffer_load_dwordx4 v[228:231], v15, s[4:7], s90 offen offset:0 sc1
    s_add_u32 s90, s90, 0x30000
    s_waitcnt vmcnt(0)
    buffer_store_dwordx4 v[228:231], v15, s[4:7], s90 offen offset:0 sc1
    s_sub_u32 s90, s90, 0x30000
    s_waitcnt vmcnt(0)
    s_lshl_b32 s90, s86, 12
    s_add_u32 s90, s90, s101
    s_add_u32 s90, s90, 0x16000
    v_lshlrev_b32 v15, 4, v1
    buffer_load_dwordx4 v[228:231], v15, s[4:7], s90 offen offset:0 sc1
    s_add_u32 s90, s90, 0x30000
    s_waitcnt vmcnt(0)
    buffer_store_dwordx4 v[228:231], v15, s[4:7], s90 offen offset:0 sc1
    s_sub_u32 s90, s90, 0x30000
    s_waitcnt vmcnt(0)
    buffer_load_dwordx4 v[228:231], v15, s[4:7], s90 offen offset:1024 sc1
    s_add_u32 s90, s90, 0x30000
    s_waitcnt vmcnt(0)
    buffer_store_dwordx4 v[228:231], v15, s[4:7], s90 offen offset:1024 sc1
    s_sub_u32 s90, s90, 0x30000
    s_waitcnt vmcnt(0)
    buffer_load_dwordx4 v[228:231], v15, s[4:7], s90 offen offset:2048 sc1
    s_add_u32 s90, s90, 0x30000
    s_waitcnt vmcnt(0)
    buffer_store_dwordx4 v[228:231], v15, s[4:7], s90 offen offset:2048 sc1
    s_sub_u32 s90, s90, 0x30000
    s_waitcnt vmcnt(0)
    buffer_load_dwordx4 v[228:231], v15, s[4:7], s90 offen offset:3072 sc1
    s_add_u32 s90, s90, 0x30000
    s_waitcnt vmcnt(0)
    buffer_store_dwordx4 v[228:231], v15, s[4:7], s90 offen offset:3072 sc1
    s_sub_u32 s90, s90, 0x30000
    s_waitcnt vmcnt(0)
    s_lshl_b32 s90, s86, 7
    s_add_u32 s90, s90, s101
    s_add_u32 s90, s90, 0x26000
    v_lshlrev_b32 v15, 4, v1
    v_and_b32 v15, 127, v15
    buffer_load_dwordx4 v[228:231], v15, s[4:7], s90 offen offset:0 sc1
    s_add_u32 s90, s90, 0x30000
    s_waitcnt vmcnt(0)
    buffer_store_dwordx4 v[228:231], v15, s[4:7], s90 offen offset:0 sc1
    s_sub_u32 s90, s90, 0x30000
    s_waitcnt vmcnt(0)
L_of_61:
    s_cmp_lg_u32 s96, 48
    s_cbranch_scc1 L_inv_65
    v_not_b32 v228, v70
    v_not_b32 v229, v70
    v_not_b32 v230, v70
    v_not_b32 v231, v70
    s_add_u32 s90, s101, 0x5c000
    buffer_store_dwordx4 v[228:231], v11, s[4:7], s90 offen offset:0 sc1
    s_add_u32 s90, s101, 0x5e000
    buffer_store_dwordx4 v[228:231], v11, s[4:7], s90 offen offset:0 sc1
    s_add_u32 s90, s101, 0x38000
    buffer_store_dwordx4 v[228:231], v11, s[4:7], s90 offen offset:0 sc1
    s_add_u32 s90, s101, 0x3a000
    buffer_store_dwordx4 v[228:231], v11, s[4:7], s90 offen offset:0 sc1
    s_waitcnt vmcnt(0)
L_inv_65:
    s_and_b32 s90, s96, 15
    s_cmp_eq_u32 s90, 15
    s_cselect_b32 s90, 0x30000, 0
    s_add_u32 s90, s90, s101
    s_add_u32 s76, s90, 0x2c000
    s_add_u32 s77, s90, 0x2e000
    s_add_u32 s78, s90, 0x8000
    s_add_u32 s79, s90, 0xa000
    s_branch L_back_60
L_rare_71:
    s_cmp_ge_u32 s96, 40000
    s_cbranch_scc1 L_ok_69
    s_and_b32 s90, s96, 63
    s_cmp_lg_u32 s90, 52
    s_cbranch_scc1 L_of_73
    s_lshl_b32 s90, s86, 10
    s_add_u32 s90, s90, s101
    s_add_u32 s90, s90, 0x0
    v_lshlrev_b32 v15, 4, v1
    buffer_load_dwordx4 v[228:231], v15, s[4:7], s90 offen offset:0 sc1
    s_add_u32 s90, s90, 0x30000
    s_waitcnt vmcnt(0)
    buffer_store_dwordx4 v[228:231], v15, s[4:7], s90 offen offset:0 sc1
    s_sub_u32 s90, s90, 0x30000
    s_waitcnt vmcnt(0)
    s_lshl_b32 s90, s86, 12
    s_add_u32 s90, s90, s101
    s_add_u32 s90, s90, 0x16000
    v_lshlrev_b32 v15, 4, v1
    buffer_load_dwordx4 v[228:231], v15, s[4:7], s90 offen offset:0 sc1
    s_add_u32 s90, s90, 0x30000
    s_waitcnt vmcnt(0)
    buffer_store_dwordx4 v[228:231], v15, s[4:7], s90 offen offset:0 sc1
    s_sub_u32 s90, s90, 0x30000
    s_waitcnt vmcnt(0)
    buffer_load_dwordx4 v[228:231], v15, s[4:7], s90 offen offset:1024 sc1
    s_add_u32 s90, s90, 0x30000
    s_waitcnt vmcnt(0)
    buffer_store_dwordx4 v[228:231], v15, s[4:7], s90 offen offset:1024 sc1
    s_sub_u32 s90, s90, 0x30000
    s_waitcnt vmcnt(0)
    buffer_load_dwordx4 v[228:231], v15, s[4:7], s90 offen offset:2048 sc1
    s_add_u32 s90, s90, 0x30000
    s_waitcnt vmcnt(0)
    buffer_store_dwordx4 v[228:231], v15, s[4:7], s90 offen offset:2048 sc1
    s_sub_u32 s90, s90, 0x30000
    s_waitcnt vmcnt(0)
    buffer_load_dwordx4 v[228:231], v15, s[4:7], s90 offen offset:3072 sc1
    s_add_u32 s90, s90, 0x30000
    s_waitcnt vmcnt(0)
    buffer_store_dwordx4 v[228:231], v15, s[4:7], s90 offen offset:3072 sc1
    s_sub_u32 s90, s90, 0x30000
    s_waitcnt vmcnt(0)
    s_lshl_b32 s90, s86, 7
    s_add_u32 s90, s90, s101
    s_add_u32 s90, s90, 0x26000
    v_lshlrev_b32 v15, 4, v1
    v_and_b32 v15, 127, v15
    buffer_load_dwordx4 v[228:231], v15, s[4:7], s90 offen offset:0 sc1
    s_add_u32 s90, s90, 0x30000
    s_waitcnt vmcnt(0)
    buffer_store_dwordx4 v[228:231], v15, s[4:7], s90 offen offset:0 sc1
    s_sub_u32 s90, s90, 0x30000
    s_waitcnt vmcnt(0)
L_of_73:
    s_and_b32 s90, s96, 15
    s_cmp_eq_u32 s90, 15
    s_cselect_b32 s90, 0x30000, 0
    s_add_u32 s90, s90, s101
    s_add_u32 s76, s90, 0x26800
    s_branch L_back_72
L_rare_80:
    s_cmp_ge_u32 s96, 40000
    s_cbranch_scc1 L_ok_78
    s_and_b32 s90, s96, 63
    s_cmp_lg_u32 s90, 52
    s_cbranch_scc1 L_of_82
    s_lshl_b32 s90, s86, 10
    s_add_u32 s90, s90, s101
    s_add_u32 s90, s90, 0x0
    v_lshlrev_b32 v15, 4, v1
    buffer_load_dwordx4 v[228:231], v15, s[4:7], s90 offen offset:0 sc1
    s_add_u32 s90, s90, 0x30000
    s_waitcnt vmcnt(0)
    buffer_store_dwordx4 v[228:231], v15, s[4:7], s90 offen offset:0 sc1
    s_sub_u32 s90, s90, 0x30000
    s_waitcnt vmcnt(0)
    s_lshl_b32 s90, s86, 12
    s_add_u32 s90, s90, s101
    s_add_u32 s90, s90, 0x16000
    v_lshlrev_b32 v15, 4, v1
    buffer_load_dwordx4 v[228:231], v15, s[4:7], s90 offen offset:0 sc1
    s_add_u32 s90, s90, 0x30000
    s_waitcnt vmcnt(0)
    buffer_store_dwordx4 v[228:231], v15, s[4:7], s90 offen offset:0 sc1
    s_sub_u32 s90, s90, 0x30000
    s_waitcnt vmcnt(0)
    buffer_load_dwordx4 v[228:231], v15, s[4:7], s90 offen offset:1024 sc1
    s_add_u32 s90, s90, 0x30000
    s_waitcnt vmcnt(0)
    buffer_store_dwordx4 v[228:231], v15, s[4:7], s90 offen offset:1024 sc1
    s_sub_u32 s90, s90, 0x30000
    s_waitcnt vmcnt(0)
    buffer_load_dwordx4 v[228:231], v15, s[4:7], s90 offen offset:2048 sc1
    s_add_u32 s90, s90, 0x30000
    s_waitcnt vmcnt(0)
    buffer_store_dwordx4 v[228:231], v15, s[4:7], s90 offen offset:2048 sc1
    s_sub_u32 s90, s90, 0x30000
    s_waitcnt vmcnt(0)
    buffer_load_dwordx4 v[228:231], v15, s[4:7], s90 offen offset:3072 sc1
    s_add_u32 s90, s90, 0x30000
    s_waitcnt vmcnt(0)
    buffer_store_dwordx4 v[228:231], v15, s[4:7], s90 offen offset:3072 sc1
    s_sub_u32 s90, s90, 0x30000
    s_waitcnt vmcnt(0)
    s_lshl_b32 s90, s86, 7
    s_add_u32 s90, s90, s101
    s_add_u32 s90, s90, 0x26000
    v_lshlrev_b32 v15, 4, v1
    v_and_b32 v15, 127, v15
    buffer_load_dwordx4 v[228:231], v15, s[4:7], s90 offen offset:0 sc1
    s_add_u32 s90, s90, 0x30000
    s_waitcnt vmcnt(0)
    buffer_store_dwordx4 v[228:231], v15, s[4:7], s90 offen offset:0 sc1
    s_sub_u32 s90, s90, 0x30000
    s_waitcnt vmcnt(0)
L_of_82:
    s_cmp_lg_u32 s96, 48
    s_cbranch_scc1 L_inv_86
    v_not_b32 v228, v70
    v_not_b32 v229, v70
    v_not_b32 v230, v70
    v_not_b32 v231, v70
    s_add_u32 s90, s101, 0x34000
    buffer_store_dwordx4 v[228:231], v11, s[4:7], s90 offen offset:0 sc1
    s_add_u32 s90, s101, 0x36000
    buffer_store_dwordx4 v[228:231], v11, s[4:7], s90 offen offset:0 sc1
    s_waitcnt vmcnt(0)
L_inv_86:
    s_and_b32 s90, s96, 15
    s_cmp_eq_u32 s90, 15
    s_cselect_b32 s90, 0x30000, 0
    s_add_u32 s90, s90, s101
    s_add_u32 s76, s90, 0x4000
    s_add_u32 s77, s90, 0x6000
    s_branch L_back_81
L_rare_90:
    s_cmp_ge_u32 s96, 40000
    s_cbranch_scc1 L_ok_88
    s_and_b32 s90, s96, 63
    s_cmp_lg_u32 s90, 52
    s_cbranch_scc1 L_of_92
    s_lshl_b32 s90, s86, 10
    s_add_u32 s90, s90, s101
    s_add_u32 s90, s90, 0x0
    v_lshlrev_b32 v15, 4, v1
    buffer_load_dwordx4 v[228:231], v15, s[4:7], s90 offen offset:0 sc1
    s_add_u32 s90, s90, 0x30000
    s_waitcnt vmcnt(0)
    buffer_store_dwordx4 v[228:231], v15, s[4:7], s90 offen offset:0 sc1
    s_sub_u32 s90, s90, 0x30000
    s_waitcnt vmcnt(0)
    s_lshl_b32 s90, s86, 12
    s_add_u32 s90, s90, s101
    s_add_u32 s90, s90, 0x16000
    v_lshlrev_b32 v15, 4, v1
    buffer_load_dwordx4 v[228:231], v15, s[4:7], s90 offen offset:0 sc1
    s_add_u32 s90, s90, 0x30000
    s_waitcnt vmcnt(0)
    buffer_store_dwordx4 v[228:231], v15, s[4:7], s90 offen offset:0 sc1
    s_sub_u32 s90, s90, 0x30000
    s_waitcnt vmcnt(0)
    buffer_load_dwordx4 v[228:231], v15, s[4:7], s90 offen offset:1024 sc1
    s_add_u32 s90, s90, 0x30000
    s_waitcnt vmcnt(0)
    buffer_store_dwordx4 v[228:231], v15, s[4:7], s90 offen offset:1024 sc1
    s_sub_u32 s90, s90, 0x30000
    s_waitcnt vmcnt(0)
    buffer_load_dwordx4 v[228:231], v15, s[4:7], s90 offen offset:2048 sc1
    s_add_u32 s90, s90, 0x30000
    s_waitcnt vmcnt(0)
    buffer_store_dwordx4 v[228:231], v15, s[4:7], s90 offen offset:2048 sc1
    s_sub_u32 s90, s90, 0x30000
    s_waitcnt vmcnt(0)
    buffer_load_dwordx4 v[228:231], v15, s[4:7], s90 offen offset:3072 sc1
    s_add_u32 s90, s90, 0x30000
    s_waitcnt vmcnt(0)
    buffer_store_dwordx4 v[228:231], v15, s[4:7], s90 offen offset:3072 sc1
    s_sub_u32 s90, s90, 0x30000
    s_waitcnt vmcnt(0)
    s_lshl_b32 s90, s86, 7
    s_add_u32 s90, s90, s101
    s_add_u32 s90, s90, 0x26000
    v_lshlrev_b32 v15, 4, v1
    v_and_b32 v15, 127, v15
    buffer_load_dwordx4 v[228:231], v15, s[4:7], s90 offen offset:0 sc1
    s_add_u32 s90, s90, 0x30000
    s_waitcnt vmcnt(0)
    buffer_store_dwordx4 v[228:231], v15, s[4:7], s90 offen offset:0 sc1
    s_sub_u32 s90, s90, 0x30000
    s_waitcnt vmcnt(0)
L_of_92:
    s_cmp_lg_u32 s96, 48
    s_cbranch_scc1 L_inv_96
    v_not_b32 v228, v70
    v_not_b32 v229, v70
    v_not_b32 v230, v70
    v_not_b32 v231, v70
    s_add_u32 s90, s101, 0x3c000
    buffer_store_dwordx4 v[228:231], v11, s[4:7], s90 offen offset:0 sc1
    s_add_u32 s90, s101, 0x3e000
    buffer_store_dwordx4 v[228:231], v11, s[4:7], s90 offen offset:0 sc1
    s_waitcnt vmcnt(0)
L_inv_96:
    s_and_b32 s90, s96, 15
    s_cmp_eq_u32 s90, 15
    s_cselect_b32 s90, 0x30000, 0
    s_add_u32 s90, s90, s101
    s_add_u32 s76, s90, 0xc000
    s_add_u32 s77, s90, 0xe000
    s_branch L_back_91
L_rare_100:
    s_cmp_ge_u32 s96, 40000
    s_cbranch_scc1 L_ok_98
    s_and_b32 s90, s96, 15
    s_cmp_eq_u32 s90, 15
    s_cselect_b32 s90, 0x30000, 0
    s_add_u32 s90, s90, s101
    s_add_u32 s76, s90, 0x28000
    s_add_u32 s77, s90, 0x2a000
    s_branch L_back_101
L_rare_105:
    s_cmp_ge_u32 s96, 40000
    s_cbranch_scc1 L_ok_103
    s_and_b32 s90, s96, 15
    s_cmp_eq_u32 s90, 15
    s_cselect_b32 s90, 0x30000, 0
    s_add_u32 s90, s90, s101
    s_add_u32 s76, s90, 0x10000
    s_add_u32 s77, s90, 0x12000
    s_branch L_back_106
L_rare_110:
    s_cmp_ge_u32 s96, 40000
    s_cbranch_scc1 L_ok_108
    s_cmp_lg_u32 s96, 48
    s_cbranch_scc1 L_inv_112
    v_not_b32 v228, v70
    v_not_b32 v229, v70
    v_not_b32 v230, v70
    v_not_b32 v231, v70
    s_add_u32 s90, s101, 0x30000
    buffer_store_dwordx4 v[228:231], v11, s[4:7], s90 offen offset:0 sc1
    s_add_u32 s90, s101, 0x32000
    buffer_store_dwordx4 v[228:231], v11, s[4:7], s90 offen offset:0 sc1
    s_waitcnt vmcnt(0)
L_inv_112:
    s_and_b32 s90, s96, 15
    s_cmp_eq_u32 s90, 15
    s_cselect_b32 s90, 0x30000, 0
    s_add_u32 s90, s90, s101
    s_add_u32 s76, s90, 0x0
    s_add_u32 s77, s90, 0x2000
    s_branch L_back_111
L_rare_117:
    s_cmp_ge_u32 s96, 40000
    s_cbranch_scc1 L_ok_115
    s_branch L_back_118
L_rare_128:
    s_cmp_ge_u32 s96, 40000
    s_cbranch_scc1 L_ok_126
    s_and_b32 s90, s96, 63
    s_cmp_lg_u32 s90, 52
    s_cbranch_scc1 L_of_130
    s_lshl_b32 s90, s86, 10
    s_add_u32 s90, s90, s101
    s_add_u32 s90, s90, 0x4000
    v_lshlrev_b32 v15, 4, v1
    buffer_load_dwordx4 v[228:231], v15, s[4:7], s90 offen offset:0 sc1
    s_add_u32 s90, s90, 0x30000
    s_waitcnt vmcnt(0)
    buffer_store_dwordx4 v[228:231], v15, s[4:7], s90 offen offset:0 sc1
    s_sub_u32 s90, s90, 0x30000
    s_waitcnt vmcnt(0)
    s_cmp_lt_u32 s86, 14
    s_cbranch_scc1 L_fs_132
    s_lshl_b32 s90, s86, 10
    s_add_u32 s90, s90, s101
    s_add_u32 s90, s90, 0x8000
    v_lshlrev_b32 v15, 4, v1
    buffer_load_dwordx4 v[228:231], v15, s[4:7], s90 offen offset:0 sc1
    s_add_u32 s90, s90, 0x30000
    s_waitcnt vmcnt(0)
    buffer_store_dwordx4 v[228:231], v15, s[4:7], s90 offen offset:0 sc1
    s_sub_u32 s90, s90, 0x30000
    s_waitcnt vmcnt(0)
L_fs_132:
    s_cmp_lt_u32 s86, 14
    s_cbranch_scc1 L_fs_133
    s_lshl_b32 s90, s86, 10
    s_add_u32 s90, s90, s101
    s_add_u32 s90, s90, 0x2c000
    v_lshlrev_b32 v15, 4, v1
    buffer_load_dwordx4 v[228:231], v15, s[4:7], s90 offen offset:0 sc1
    s_add_u32 s90, s90, 0x30000
    s_waitcnt vmcnt(0)
    buffer_store_dwordx4 v[228:231], v15, s[4:7], s90 offen offset:0 sc1
    s_sub_u32 s90, s90, 0x30000
    s_waitcnt vmcnt(0)
L_fs_133:
L_of_130:
    s_branch L_back_129
L_rare_141:
    s_cmp_ge_u32 s96, 40000
    s_cbranch_scc1 L_ok_139
    s_and_b32 s90, s96, 63
    s_cmp_lg_u32 s90, 52
    s_cbranch_scc1 L_of_143
    s_lshl_b32 s90, s86, 10
    s_add_u32 s90, s90, s101
    s_add_u32 s90, s90, 0x4000
    v_lshlrev_b32 v15, 4, v1
    buffer_load_dwordx4 v[228:231], v15, s[4:7], s90 offen offset:0 sc1
    s_add_u32 s90, s90, 0x30000
    s_waitcnt vmcnt(0)
    buffer_store_dwordx4 v[228:231], v15, s[4:7], s90 offen offset:0 sc1
    s_sub_u32 s90, s90, 0x30000
    s_waitcnt vmcnt(0)
    s_cmp_lt_u32 s86, 14
    s_cbranch_scc1 L_fs_145
    s_lshl_b32 s90, s86, 10
    s_add_u32 s90, s90, s101
    s_add_u32 s90, s90, 0x8000
    v_lshlrev_b32 v15, 4, v1
    buffer_load_dwordx4 v[228:231], v15, s[4:7], s90 offen offset:0 sc1
    s_add_u32 s90, s90, 0x30000
    s_waitcnt vmcnt(0)
    buffer_store_dwordx4 v[228:231], v15, s[4:7], s90 offen offset:0 sc1
    s_sub_u32 s90, s90, 0x30000
    s_waitcnt vmcnt(0)
L_fs_145:
    s_cmp_lt_u32 s86, 14
    s_cbranch_scc1 L_fs_146
    s_lshl_b32 s90, s86, 10
    s_add_u32 s90, s90, s101
    s_add_u32 s90, s90, 0x2c000
    v_lshlrev_b32 v15, 4, v1
    buffer_load_dwordx4 v[228:231], v15, s[4:7], s90 offen offset:0 sc1
    s_add_u32 s90, s90, 0x30000
    s_waitcnt vmcnt(0)
    buffer_store_dwordx4 v[228:231], v15, s[4:7], s90 offen offset:0 sc1
    s_sub_u32 s90, s90, 0x30000
    s_waitcnt vmcnt(0)
L_fs_146:
    s_lshl_b32 s90, s86, 10
    s_add_u32 s90, s90, s101
    s_add_u32 s90, s90, 0xc000
    v_lshlrev_b32 v15, 4, v1
    buffer_load_dwordx4 v[228:231], v15, s[4:7], s90 offen offset:0 sc1
    s_add_u32 s90, s90, 0x30000
    s_waitcnt vmcnt(0)
    buffer_store_dwordx4 v[228:231], v15, s[4:7], s90 offen offset:0 sc1
    s_sub_u32 s90, s90, 0x30000
    s_waitcnt vmcnt(0)
L_of_143:
    s_branch L_back_142
L_exit:
    s_endpgm
.fill (20480 - (. - adaLN_cond__sliding_block_cached__dense_activation_relu__decode_kernel)) / 4, 4, 0xbf810000
.section .rodata,"a"
.p2align 6
.amdhsa_kernel adaLN_cond__sliding_block_cached__dense_activation_relu__decode_kernel
  .amdhsa_next_free_vgpr 256
  .amdhsa_next_free_sgpr 102
  .amdhsa_accum_offset 256
  .amdhsa_group_segment_fixed_size 0
  .amdhsa_kernarg_size 104
  .amdhsa_user_sgpr_count 2
  .amdhsa_user_sgpr_kernarg_segment_ptr 1
  .amdhsa_system_sgpr_workgroup_id_x 1
  .amdhsa_float_denorm_mode_32 3
.end_amdhsa_kernel
```
